```python
import torch

def _softmax(x, axis=-1):
    return torch.softmax(x, dim=axis)
def _gelu(x):
    return torch.nn.functional.gelu(x, approximate="tanh")
def _silu(x):
    return torch.nn.functional.silu(x)
def _sigmoid(x):
    return torch.sigmoid(x)
def _layernorm(x, axis=-1, eps=1e-5):
    m = x.mean(dim=axis, keepdim=True)
    v = x.var(dim=axis, keepdim=True, unbiased=False)
    return (x - m) / torch.sqrt(v + eps)
def _scatter_add(tgt, idx, src, axis=0):
    return tgt.clone().index_add_(axis, idx, src)
def _segment_sum(src, seg, n):
    out = torch.zeros((n,) + src.shape[1:], dtype=src.dtype)
    return out.index_add_(0, seg, src)
def _pad(x, pw):
    flat = tuple(v for pair in reversed(pw) for v in pair)
    return torch.nn.functional.pad(x, flat)

kernel_name = 'standalone__edge_featured_mpnn_gatedgcn__graph'

def setup_inputs():

    _w = (lambda a: (lambda t: t.to(torch.bfloat16) if t.is_floating_point() else t)(torch.as_tensor(a)))
    N, deg, D, De = 10000, 32, 128, max(16, 1)
    E = N * deg
    return {
        "x": _w((lambda *s: torch.randn(*s, dtype=torch.bfloat16) * 0.4)(N, D)),
        "e_attr": _w((lambda *s: torch.randn(*s, dtype=torch.bfloat16) * 0.8)(E, De)),
        "src": _w((lambda lo, hi, *s: torch.randint(lo, hi, s))(0, N, E).to(torch.int64)),
        "dst": _w((lambda lo, hi, *s: torch.randint(lo, hi, s))(0, N, E).to(torch.int64)),
        "w_a": _w((lambda *s: torch.randn(*s, dtype=torch.bfloat16) * 0.4)(D, D)),
        "w_b": _w((lambda *s: torch.randn(*s, dtype=torch.bfloat16) * 0.4)(D, D)),
        "w_c": _w((lambda *s: torch.randn(*s, dtype=torch.bfloat16) * 0.8)(De, D)),
        "w_u": _w((lambda *s: torch.randn(*s, dtype=torch.bfloat16) * 0.05)(D, D)),
        "w_v": _w((lambda *s: torch.randn(*s, dtype=torch.bfloat16) * 0.05)(D, D)),
    }

def reference(x, e_attr, src, dst, w_a, w_b, w_c, w_u, w_v):
    N, D = x.shape
    hv = x @ w_v
    g = x[dst] @ w_a + x[src] @ w_b + e_attr @ w_c
    eta = _sigmoid(g)
    denom = _segment_sum(eta, dst, N) + 1e-6
    eta_n = eta / denom[dst]
    agg = _segment_sum(eta_n * hv[src], dst, N)
    z = x @ w_u + agg
    relu_z = torch.where(z > 0, z, 0 * z)
    return x + relu_z
```

```asm
; @launch kernel=gcn_prep_kernel grid=(256,1,1) block=(1024,1,1) lds=116992
; @launch kernel=gcn_main_kernel grid=(256,1,1) block=(1024,1,1) lds=163840
.amdgcn_target "amdgcn-amd-amdhsa--gfx950"
.text
.globl gcn_prep_kernel
.p2align 8
.type gcn_prep_kernel,@function
gcn_prep_kernel:
    s_cmp_ge_u32 s2, 256
    s_cbranch_scc1 K1_END
    s_load_dwordx16 s[4:19], s[0:1], 0
    s_load_dwordx8 s[20:27], s[0:1], 64
    v_lshrrev_b32 v2, 6, v0
    v_mov_b32 v1, v0
    v_readfirstlane_b32 s28, v2
    v_and_b32 v0, 63, v0
    s_cmp_ge_u32 s2, 125
    s_cbranch_scc1 K1_TAB
    s_cmp_ge_u32 s28, 10
    s_cbranch_scc1 K1_Z
    s_setprio 3
    s_mul_i32 s33, s2, 10240
    v_lshl_add_u32 v80, v1, 4, s33
    s_waitcnt lgkmcnt(0)
    global_load_dwordx4 v[4:7], v80, s[10:11] nt
    global_load_dwordx4 v[8:11], v80, s[8:9] nt
    s_setprio 0
    s_branch K1_E
K1_Z:
    v_lshlrev_b32 v2, 3, v0
    v_mov_b64 v[84:85], 0
    ds_write_b64 v2, v[84:85] offset:0
K1_E:
    s_mul_i32 s34, s28, 5120
    s_mul_i32 s33, s2, 81920
    s_add_u32 s35, s33, s34
    v_lshl_add_u32 v81, v0, 4, s35
    s_add_u32 m0, s34, 16640
    v_add_u32 v82, 0x1000, v81
    s_add_u32 s33, s33, 5242880
    v_lshl_add_u32 v60, v1, 4, s33
    v_and_b32 v58, -2, v1
    v_and_b32 v59, 1, v0
    v_lshlrev_b32 v59, 4, v59
    s_waitcnt lgkmcnt(0)
    global_load_lds_dwordx4 v81, s[6:7] offset:0 nt
    global_load_lds_dwordx4 v81, s[6:7] offset:1024 nt
    global_load_lds_dwordx4 v81, s[6:7] offset:2048 nt
    global_load_lds_dwordx4 v81, s[6:7] offset:3072 nt
    s_add_u32 m0, s34, 20736
    s_movk_i32 s35, 13421
    global_load_lds_dwordx4 v82, s[6:7] nt
    s_mov_b32 s36, 5120290
    v_mov_b32 v84, 1
    v_mov_b32 v85, 0xffff
    s_barrier
    s_cmp_ge_u32 s28, 10
    s_cbranch_scc1 K1_B1
    s_waitcnt vmcnt(5)
    v_mul_u32_u24 v16, s35, v4
    v_mul_u32_u24 v17, s35, v5
    v_mul_u32_u24 v18, s35, v6
    v_mul_u32_u24 v19, s35, v7
    v_lshrrev_b32 v16, 20, v16
    v_lshrrev_b32 v17, 20, v17
    v_lshrrev_b32 v18, 20, v18
    v_lshrrev_b32 v19, 20, v19
    v_mad_u32_u24 v20, v16, s36, v85
    v_mad_u32_u24 v21, v17, s36, v85
    v_mad_u32_u24 v22, v18, s36, v85
    v_mad_u32_u24 v23, v19, s36, v85
    v_lshlrev_b32 v16, 2, v16
    ds_add_rtn_u32 v12, v16, v84 offset:0
    v_lshlrev_b32 v17, 2, v17
    ds_add_rtn_u32 v13, v17, v84 offset:0
    v_lshlrev_b32 v18, 2, v18
    ds_add_rtn_u32 v14, v18, v84 offset:0
    v_lshlrev_b32 v19, 2, v19
    ds_add_rtn_u32 v15, v19, v84 offset:0
    v_lshrrev_b32 v20, 16, v20
    v_lshrrev_b32 v21, 16, v21
    v_lshrrev_b32 v22, 16, v22
    v_lshrrev_b32 v23, 16, v23
    v_sub_u32 v20, v4, v20
    v_sub_u32 v21, v5, v21
    v_sub_u32 v22, v6, v22
    v_sub_u32 v23, v7, v23
    v_mul_u32_u24 v4, 13, v8
    v_mul_u32_u24 v5, 13, v9
    v_mul_u32_u24 v6, 13, v10
    v_mul_u32_u24 v7, 13, v11
    v_lshrrev_b32 v4, 15, v4
    v_lshrrev_b32 v5, 15, v5
    v_lshrrev_b32 v6, 15, v6
    v_lshrrev_b32 v7, 15, v7
    v_lshl_add_u32 v20, v20, 2, v4
    v_lshl_add_u32 v21, v21, 2, v5
    v_lshl_add_u32 v22, v22, 2, v6
    v_lshl_add_u32 v23, v23, 2, v7
    v_lshlrev_b32 v20, 2, v20
    v_lshlrev_b32 v21, 2, v21
    v_lshlrev_b32 v22, 2, v22
    v_lshlrev_b32 v23, 2, v23
    v_lshl_or_b32 v20, v8, 16, v20
    v_lshl_or_b32 v21, v9, 16, v21
    v_lshl_or_b32 v22, v10, 16, v22
    v_lshl_or_b32 v23, v11, 16, v23
    v_lshlrev_b32 v4, 6, v1
    v_add_u32 v5, 16, v4
    v_add_u32 v6, 32, v4
    v_add_u32 v7, 48, v4
    s_waitcnt lgkmcnt(0)
K1_B1:
    s_barrier
    s_cmp_lg_u32 s28, 15
    s_cbranch_scc1 K1_B2
    ds_read_b64 v[88:89], v2 offset:0
    s_and_b32 s33, s2, 15
    s_lshr_b32 s34, s2, 4
    s_lshl3_add_u32 s33, s33, s34
    s_lshl_b32 s33, s33, 10
    s_add_u32 s33, s33, 17825792
    v_lshl_add_u32 v3, v0, 4, s33
    s_mul_i32 s33, s2, 10240
    s_waitcnt lgkmcnt(0)
    v_add_u32 v90, v88, v89
    v_mov_b32 v91, v90
    s_nop 1
    v_add_u32_dpp v90, v90, v90 row_shr:1 row_mask:0xf bank_mask:0xf
    s_nop 1
    v_add_u32_dpp v90, v90, v90 row_shr:2 row_mask:0xf bank_mask:0xf
    s_nop 1
    v_add_u32_dpp v90, v90, v90 row_shr:4 row_mask:0xf bank_mask:0xf
    s_nop 1
    v_add_u32_dpp v90, v90, v90 row_shr:8 row_mask:0xf bank_mask:0xf
    s_nop 1
    v_add_u32_dpp v90, v90, v90 row_bcast:15 row_mask:0xa bank_mask:0xf
    s_nop 1
    v_add_u32_dpp v90, v90, v90 row_bcast:31 row_mask:0xc bank_mask:0xf
    v_sub_u32 v90, v90, v91
    v_add_u32 v91, v90, v88
    v_lshlrev_b32 v90, 2, v90
    v_lshlrev_b32 v91, 2, v91
    ds_write_b64 v2, v[90:91] offset:768
    v_add_u32 v76, s33, v90
    v_mov_b32 v77, v88
    v_add_u32 v78, s33, v91
    v_mov_b32 v79, v89
    global_store_dwordx4 v3, v[76:79], s[26:27] sc1
    s_waitcnt lgkmcnt(0)
K1_B2:
    s_barrier
    s_cmp_ge_u32 s28, 10
    s_cbranch_scc1 K1_B3
    ds_read_b32 v16, v16 offset:768
    ds_read_b32 v17, v17 offset:768
    ds_read_b32 v18, v18 offset:768
    ds_read_b32 v19, v19 offset:768
    s_waitcnt lgkmcnt(0)
    v_lshl_add_u32 v16, v12, 2, v16
    ds_write_b32 v16, v20 offset:1280
    v_lshl_add_u32 v17, v13, 2, v17
    ds_write_b32 v17, v21 offset:1280
    v_lshl_add_u32 v18, v14, 2, v18
    ds_write_b32 v18, v22 offset:1280
    v_lshl_add_u32 v19, v15, 2, v19
    ds_write_b32 v19, v23 offset:1280
    v_lshrrev_b32 v12, 1, v16
    ds_write_b16 v12, v4 offset:11520
    v_lshrrev_b32 v13, 1, v17
    ds_write_b16 v13, v5 offset:11520
    v_lshrrev_b32 v14, 1, v18
    ds_write_b16 v14, v6 offset:11520
    v_lshrrev_b32 v15, 1, v19
    ds_write_b16 v15, v7 offset:11520
K1_B3:
    s_cmp_eq_u32 s28, 15
    s_cbranch_scc1 K1_B4
    s_waitcnt vmcnt(0)
K1_B4:
    s_waitcnt vmcnt(1) lgkmcnt(0)
    s_barrier
    ds_read_u16 v4, v58 offset:11520
    ds_read_u16 v5, v58 offset:12544
    ds_read_u16 v6, v58 offset:13568
    ds_read_u16 v7, v58 offset:14592
    ds_read_u16 v8, v58 offset:15616
    s_cmp_ge_u32 s28, 10
    s_cbranch_scc1 K1_O3
    v_lshlrev_b32 v10, 4, v1
    ds_read_b128 v[48:51], v10 offset:1280
    s_mul_i32 s33, s2, 10240
    s_add_u32 s33, s33, 15728640
    v_add_u32 v10, s33, v10
    s_waitcnt lgkmcnt(0)
    global_store_dwordx4 v10, v[48:51], s[26:27] sc1
K1_O3:
    s_waitcnt lgkmcnt(0)
    v_lshl_or_b32 v4, v4, 1, v59
    ds_read_b128 v[20:23], v4 offset:16640
    v_lshl_or_b32 v5, v5, 1, v59
    ds_read_b128 v[24:27], v5 offset:16640
    v_lshl_or_b32 v6, v6, 1, v59
    ds_read_b128 v[28:31], v6 offset:16640
    v_lshl_or_b32 v7, v7, 1, v59
    ds_read_b128 v[32:35], v7 offset:16640
    v_lshl_or_b32 v8, v8, 1, v59
    ds_read_b128 v[36:39], v8 offset:16640
    v_add_u32 v61, 16384, v60
    v_add_u32 v62, 32768, v60
    v_add_u32 v63, 49152, v60
    v_add_u32 v64, 65536, v60
    s_waitcnt lgkmcnt(4)
    global_store_dwordx4 v60, v[20:23], s[26:27] sc1
    s_waitcnt lgkmcnt(3)
    global_store_dwordx4 v61, v[24:27], s[26:27] sc1
    s_waitcnt lgkmcnt(2)
    global_store_dwordx4 v62, v[28:31], s[26:27] sc1
    s_waitcnt lgkmcnt(1)
    global_store_dwordx4 v63, v[32:35], s[26:27] sc1
    s_waitcnt lgkmcnt(0)
    global_store_dwordx4 v64, v[36:39], s[26:27] sc1
K1_FIN:
    s_endpgm
K1_TAB:
    s_cmp_lt_u32 s2, 128
    s_cbranch_scc1 K1_SPARE
    s_bfe_u32 s29, s2, 0x10002
    s_lshr_b32 s75, s2, 3
    s_sub_u32 s75, s75, 16
    s_and_b32 s30, s2, 3
    s_lshl_b32 s30, s30, 5
    s_lshl1_add_u32 s30, s75, s30
    s_mul_i32 s31, s30, 5120290
    s_add_u32 s31, s31, 65535
    s_lshr_b32 s31, s31, 16
    s_setprio 3
    v_lshrrev_b32 v81, 4, v0
    v_lshl_add_u32 v81, s28, 2, v81
    v_xor_b32 v92, v81, v0
    v_and_b32 v92, 15, v92
    v_lshlrev_b32 v92, 4, v92
    v_add_u32 v81, s31, v81
    v_lshl_add_u32 v92, v81, 8, v92
    s_and_b32 s35, s28, 1
    s_lshl_b32 s35, s35, 2
    v_bfe_u32 v84, v0, 4, 1
    v_lshl_or_b32 v84, v84, 1, s35
    v_xor_b32 v84, v84, v0
    v_and_b32 v84, 7, v84
    s_lshl_b32 s35, s28, 11
    s_lshl_b32 s36, s29, 7
    s_add_u32 s35, s35, s36
    v_lshl_add_u32 v82, v84, 4, s35
    v_lshrrev_b32 v84, 3, v0
    v_lshl_add_u32 v82, v84, 8, v82
    s_lshl_b32 s35, s28, 10
    s_add_u32 m0, s35, 256
    s_waitcnt lgkmcnt(0)
    global_load_lds_dwordx4 v82, s[14:15]
    s_add_u32 m0, s35, 16640
    s_nop 0
    global_load_lds_dwordx4 v82, s[20:21]
    s_mov_b32 s40, s4
    s_mov_b32 s41, s5
    s_mov_b32 s42, 2560000
    s_mov_b32 s43, 0x20000
    s_add_u32 s76, s35, 33024
    s_add_u32 m0, s76, 0
    s_mov_b32 s77, 0
    buffer_load_dwordx4 v92, s[40:43], s77 offen  lds
    s_setprio 2
    s_add_u32 m0, s76, 16384
    s_mov_b32 s77, 16384
    buffer_load_dwordx4 v92, s[40:43], s77 offen  lds
    s_setprio 0
    s_cmp_lg_u32 s75, 15
    s_cbranch_scc1 K1_NCP
    s_cmp_lt_u32 s28, 14
    s_cbranch_scc1 K1_NCP
    s_getpc_b64 s[72:73]
K1_PC:
    s_and_b32 s33, s28, 1
    s_lshl_b32 s33, s33, 13
    s_add_u32 s33, s33, gcn_main_kernel-K1_PC
    v_lshl_add_u32 v94, v0, 7, s33
    v_min_u32 v94, K2_END-K1_PC, v94
    global_load_dword v94, v94, s[72:73]
    s_branch K1_NCQ
K1_NCP:
    s_cmp_lt_u32 s28, 8
    s_cselect_b64 exec, -1, 0
    s_add_u32 m0, s76, 32768
    s_mov_b32 s77, 32768
    buffer_load_dwordx4 v92, s[40:43], s77 offen  lds
    s_mov_b64 exec, -1
K1_NCQ:
    s_and_b32 s34, s28, 3
    s_lshr_b32 s33, s28, 2
    s_lshl_b32 s33, s33, 12
    s_add_u32 s33, s33, 33024
    v_and_b32 v84, 15, v0
    v_lshrrev_b32 v85, 4, v0
    v_xor_b32 v85, v84, v85
    v_lshl_add_u32 v85, v85, 4, s33
    v_lshl_add_u32 v14, v84, 8, v85
    v_xor_b32 v15, 64, v14
    v_xor_b32 v16, 0x80, v14
    v_xor_b32 v17, 0xc0, v14
    v_and_b32 v84, 0x30, v0
    v_lshlrev_b32 v18, 6, v84
    v_and_b32 v84, 12, v0
    v_lshl_or_b32 v18, v84, 5, v18
    v_bfe_u32 v84, v0, 3, 2
    v_xor_b32 v84, s34, v84
    v_lshl_or_b32 v18, v84, 5, v18
    v_and_b32 v84, 3, v0
    v_lshl_or_b32 v18, v84, 3, v18
    v_add_u32 v18, 256, v18
    s_lshr_b32 s33, s28, 2
    s_mul_i32 s33, s33, 4352
    s_lshl_b32 s34, s34, 6
    s_add_u32 s33, s33, s34
    s_add_u32 s33, s33, 82176
    s_movk_i32 s34, 272
    v_and_b32 v84, 48, v0
    v_add_u32 v84, s33, v84
    v_and_b32 v85, 15, v0
    v_mad_u32_u24 v19, v85, s34, v84
    v_lshrrev_b32 v86, 4, v1
    v_lshlrev_b32 v85, 4, v85
    v_mad_u32_u24 v87, v86, s34, v85
    v_add_u32 v87, 82176, v87
    v_add_u32 v86, s31, v86
    v_lshl_add_u32 v86, v86, 8, v85
    s_mul_i32 s35, s29, 2560256
    s_add_u32 s64, s26, s35
    s_addc_u32 s65, s27, 0
    s_add_u32 s33, s30, 2
    s_mul_i32 s33, s33, 5120290
    s_add_u32 s33, s33, 65535
    s_lshr_b32 s33, s33, 16
    s_min_u32 s33, s33, 10000
    s_lshl_b32 s66, s33, 8
    s_mov_b32 s67, 0x20000
    s_mov_b32 s38, 0xbfb8aa3b
    s_mov_b32 s39, 0x07060302
    s_mov_b32 s37, 0x80000000
    s_mov_b32 s69, 0xc2f00000
    v_mov_b32 v84, 0
    ds_write_b32 v84, v84 offset:0
    s_waitcnt vmcnt(2) lgkmcnt(0)
    s_barrier
    ds_read_b64_tr_b16 v[36:37], v18 offset:0
    ds_read_b64_tr_b16 v[38:39], v18 offset:512
    ds_read_b64_tr_b16 v[40:41], v18 offset:4096
    ds_read_b64_tr_b16 v[42:43], v18 offset:4608
    ds_read_b64_tr_b16 v[44:45], v18 offset:8192
    ds_read_b64_tr_b16 v[46:47], v18 offset:8704
    ds_read_b64_tr_b16 v[48:49], v18 offset:12288
    ds_read_b64_tr_b16 v[50:51], v18 offset:12800
    ds_read_b64_tr_b16 v[52:53], v18 offset:16384
    ds_read_b64_tr_b16 v[54:55], v18 offset:16896
    ds_read_b64_tr_b16 v[56:57], v18 offset:20480
    ds_read_b64_tr_b16 v[58:59], v18 offset:20992
    ds_read_b64_tr_b16 v[60:61], v18 offset:24576
    ds_read_b64_tr_b16 v[62:63], v18 offset:25088
    ds_read_b64_tr_b16 v[64:65], v18 offset:28672
    ds_read_b64_tr_b16 v[66:67], v18 offset:29184
    ds_read_b128 v[20:23], v14 offset:0
    ds_read_b128 v[24:27], v15 offset:0
    ds_read_b128 v[28:31], v16 offset:0
    ds_read_b128 v[32:35], v17 offset:0
    s_waitcnt lgkmcnt(0)
    v_mfma_f32_16x16x32_bf16 v[68:71], v[36:39], v[20:23], 0
    v_mfma_f32_16x16x32_bf16 v[72:75], v[52:55], v[20:23], 0
    v_mfma_f32_16x16x32_bf16 v[68:71], v[40:43], v[24:27], v[68:71]
    v_mfma_f32_16x16x32_bf16 v[72:75], v[56:59], v[24:27], v[72:75]
    v_mfma_f32_16x16x32_bf16 v[68:71], v[44:47], v[28:31], v[68:71]
    v_mfma_f32_16x16x32_bf16 v[72:75], v[60:63], v[28:31], v[72:75]
    v_mfma_f32_16x16x32_bf16 v[68:71], v[48:51], v[32:35], v[68:71]
    v_mfma_f32_16x16x32_bf16 v[72:75], v[64:67], v[32:35], v[72:75]
    v_mov_b32 v84, s38
    s_nop 6
    v_fmaak_f32 v68, v84, v68, 0xc2200000
    v_fmaak_f32 v69, v84, v69, 0xc2200000
    v_fmaak_f32 v70, v84, v70, 0xc2200000
    v_fmaak_f32 v71, v84, v71, 0xc2200000
    v_max3_f32 v76, v68, v69, v70
    v_min3_f32 v77, v68, v69, v70
    v_max_f32 v76, v76, v71
    v_min_f32 v77, v77, v71
    v_cmp_lt_f32 vcc, 0x42200000, v76
    v_cmp_gt_f32 s[70:71], s69, v77
    v_exp_f32 v80, v68
    v_exp_f32 v81, v69
    v_exp_f32 v82, v70
    v_exp_f32 v83, v71
    s_or_b64 s[70:71], vcc, s[70:71]
    s_cbranch_scc0 .L0_1
    v_mov_b32 v76, 0x42200000
    v_mov_b32 v77, 0
    v_mov_b32 v78, 1
    ds_write_b32 v77, v78 offset:0
    v_med3_f32 v77, v68, s69, v76
    v_add_f32 v78, v68, v76
    v_cmp_neq_f32 vcc, v77, v68
    v_lshrrev_b32 v78, 1, v78
    v_or_b32 v78, s37, v78
    v_cndmask_b32 v80, v80, v78, vcc
    v_med3_f32 v77, v69, s69, v76
    v_add_f32 v78, v69, v76
    v_cmp_neq_f32 vcc, v77, v69
    v_lshrrev_b32 v78, 1, v78
    v_or_b32 v78, s37, v78
    v_cndmask_b32 v81, v81, v78, vcc
    v_med3_f32 v77, v70, s69, v76
    v_add_f32 v78, v70, v76
    v_cmp_neq_f32 vcc, v77, v70
    v_lshrrev_b32 v78, 1, v78
    v_or_b32 v78, s37, v78
    v_cndmask_b32 v82, v82, v78, vcc
    v_med3_f32 v77, v71, s69, v76
    v_add_f32 v78, v71, v76
    v_cmp_neq_f32 vcc, v77, v71
    v_lshrrev_b32 v78, 1, v78
    v_or_b32 v78, s37, v78
    v_cndmask_b32 v83, v83, v78, vcc
.L0_1:
    v_add_u32 v80, 0x8000, v80
    v_add_u32 v81, 0x8000, v81
    v_add_u32 v82, 0x8000, v82
    v_add_u32 v83, 0x8000, v83
    v_add_u32 v72, 0x5480, v72
    v_add_u32 v73, 0x5480, v73
    v_add_u32 v74, 0x5480, v74
    v_add_u32 v75, 0x5480, v75
    v_lshrrev_b32 v76, 16, v72
    v_lshrrev_b32 v78, 16, v74
    v_sub_u32 v81, v81, v76
    v_sub_u32 v83, v83, v78
    v_perm_b32 v80, v72, v80, s39
    v_perm_b32 v81, v73, v81, s39
    v_perm_b32 v82, v74, v82, s39
    v_perm_b32 v83, v75, v83, s39
    ds_write_b128 v19, v[80:83] offset:0
    s_waitcnt vmcnt(1) lgkmcnt(0)
    s_barrier
    ds_read_b128 v[88:91], v87 offset:0
    ds_read_b128 v[20:23], v14 offset:16384
    ds_read_b128 v[24:27], v15 offset:16384
    ds_read_b128 v[28:31], v16 offset:16384
    ds_read_b128 v[32:35], v17 offset:16384
    s_waitcnt lgkmcnt(4)
    buffer_store_dwordx4 v[88:91], v86, s[64:67], 0 offen sc1
    s_waitcnt lgkmcnt(0)
    v_mfma_f32_16x16x32_bf16 v[68:71], v[36:39], v[20:23], 0
    v_mfma_f32_16x16x32_bf16 v[72:75], v[52:55], v[20:23], 0
    v_mfma_f32_16x16x32_bf16 v[68:71], v[40:43], v[24:27], v[68:71]
    v_mfma_f32_16x16x32_bf16 v[72:75], v[56:59], v[24:27], v[72:75]
    v_mfma_f32_16x16x32_bf16 v[68:71], v[44:47], v[28:31], v[68:71]
    v_mfma_f32_16x16x32_bf16 v[72:75], v[60:63], v[28:31], v[72:75]
    v_mfma_f32_16x16x32_bf16 v[68:71], v[48:51], v[32:35], v[68:71]
    v_mfma_f32_16x16x32_bf16 v[72:75], v[64:67], v[32:35], v[72:75]
    v_mov_b32 v84, s38
    s_nop 6
    v_fmaak_f32 v68, v84, v68, 0xc2200000
    v_fmaak_f32 v69, v84, v69, 0xc2200000
    v_fmaak_f32 v70, v84, v70, 0xc2200000
    v_fmaak_f32 v71, v84, v71, 0xc2200000
    v_max3_f32 v76, v68, v69, v70
    v_min3_f32 v77, v68, v69, v70
    v_max_f32 v76, v76, v71
    v_min_f32 v77, v77, v71
    v_cmp_lt_f32 vcc, 0x42200000, v76
    v_cmp_gt_f32 s[70:71], s69, v77
    v_exp_f32 v80, v68
    v_exp_f32 v81, v69
    v_exp_f32 v82, v70
    v_exp_f32 v83, v71
    s_or_b64 s[70:71], vcc, s[70:71]
    s_cbranch_scc0 .L0_2
    v_mov_b32 v76, 0x42200000
    v_mov_b32 v77, 0
    v_mov_b32 v78, 1
    ds_write_b32 v77, v78 offset:0
    v_med3_f32 v77, v68, s69, v76
    v_add_f32 v78, v68, v76
    v_cmp_neq_f32 vcc, v77, v68
    v_lshrrev_b32 v78, 1, v78
    v_or_b32 v78, s37, v78
    v_cndmask_b32 v80, v80, v78, vcc
    v_med3_f32 v77, v69, s69, v76
    v_add_f32 v78, v69, v76
    v_cmp_neq_f32 vcc, v77, v69
    v_lshrrev_b32 v78, 1, v78
    v_or_b32 v78, s37, v78
    v_cndmask_b32 v81, v81, v78, vcc
    v_med3_f32 v77, v70, s69, v76
    v_add_f32 v78, v70, v76
    v_cmp_neq_f32 vcc, v77, v70
    v_lshrrev_b32 v78, 1, v78
    v_or_b32 v78, s37, v78
    v_cndmask_b32 v82, v82, v78, vcc
    v_med3_f32 v77, v71, s69, v76
    v_add_f32 v78, v71, v76
    v_cmp_neq_f32 vcc, v77, v71
    v_lshrrev_b32 v78, 1, v78
    v_or_b32 v78, s37, v78
    v_cndmask_b32 v83, v83, v78, vcc
.L0_2:
    v_add_u32 v80, 0x8000, v80
    v_add_u32 v81, 0x8000, v81
    v_add_u32 v82, 0x8000, v82
    v_add_u32 v83, 0x8000, v83
    v_add_u32 v72, 0x5480, v72
    v_add_u32 v73, 0x5480, v73
    v_add_u32 v74, 0x5480, v74
    v_add_u32 v75, 0x5480, v75
    v_lshrrev_b32 v76, 16, v72
    v_lshrrev_b32 v78, 16, v74
    v_sub_u32 v81, v81, v76
    v_sub_u32 v83, v83, v78
    v_perm_b32 v80, v72, v80, s39
    v_perm_b32 v81, v73, v81, s39
    v_perm_b32 v82, v74, v82, s39
    v_perm_b32 v83, v75, v83, s39
    ds_write_b128 v19, v[80:83] offset:17408
    s_cmp_ge_u32 s28, 8
    s_cbranch_scc1 K1_T2
    s_waitcnt vmcnt(1)
K1_T2:
    s_waitcnt lgkmcnt(0)
    s_barrier
    s_cmp_ge_u32 s28, 8
    s_cbranch_scc1 K1_TL
    ds_read_b128 v[88:91], v87 offset:17408
    s_mov_b32 s33, 16384
    ds_read_b128 v[20:23], v14 offset:32768
    ds_read_b128 v[24:27], v15 offset:32768
    ds_read_b128 v[28:31], v16 offset:32768
    ds_read_b128 v[32:35], v17 offset:32768
    s_waitcnt lgkmcnt(4)
    buffer_store_dwordx4 v[88:91], v86, s[64:67], s33 offen sc1
    s_waitcnt lgkmcnt(0)
    v_mfma_f32_16x16x32_bf16 v[68:71], v[36:39], v[20:23], 0
    v_mfma_f32_16x16x32_bf16 v[72:75], v[52:55], v[20:23], 0
    v_mfma_f32_16x16x32_bf16 v[68:71], v[40:43], v[24:27], v[68:71]
    v_mfma_f32_16x16x32_bf16 v[72:75], v[56:59], v[24:27], v[72:75]
    v_mfma_f32_16x16x32_bf16 v[68:71], v[44:47], v[28:31], v[68:71]
    v_mfma_f32_16x16x32_bf16 v[72:75], v[60:63], v[28:31], v[72:75]
    v_mfma_f32_16x16x32_bf16 v[68:71], v[48:51], v[32:35], v[68:71]
    v_mfma_f32_16x16x32_bf16 v[72:75], v[64:67], v[32:35], v[72:75]
    v_mov_b32 v84, s38
    s_nop 6
    v_fmaak_f32 v68, v84, v68, 0xc2200000
    v_fmaak_f32 v69, v84, v69, 0xc2200000
    v_fmaak_f32 v70, v84, v70, 0xc2200000
    v_fmaak_f32 v71, v84, v71, 0xc2200000
    v_max3_f32 v76, v68, v69, v70
    v_min3_f32 v77, v68, v69, v70
    v_max_f32 v76, v76, v71
    v_min_f32 v77, v77, v71
    v_cmp_lt_f32 vcc, 0x42200000, v76
    v_cmp_gt_f32 s[70:71], s69, v77
    v_exp_f32 v80, v68
    v_exp_f32 v81, v69
    v_exp_f32 v82, v70
    v_exp_f32 v83, v71
    s_or_b64 s[70:71], vcc, s[70:71]
    s_cbranch_scc0 .L0_3
    v_mov_b32 v76, 0x42200000
    v_mov_b32 v77, 0
    v_mov_b32 v78, 1
    ds_write_b32 v77, v78 offset:0
    v_med3_f32 v77, v68, s69, v76
    v_add_f32 v78, v68, v76
    v_cmp_neq_f32 vcc, v77, v68
    v_lshrrev_b32 v78, 1, v78
    v_or_b32 v78, s37, v78
    v_cndmask_b32 v80, v80, v78, vcc
    v_med3_f32 v77, v69, s69, v76
    v_add_f32 v78, v69, v76
    v_cmp_neq_f32 vcc, v77, v69
    v_lshrrev_b32 v78, 1, v78
    v_or_b32 v78, s37, v78
    v_cndmask_b32 v81, v81, v78, vcc
    v_med3_f32 v77, v70, s69, v76
    v_add_f32 v78, v70, v76
    v_cmp_neq_f32 vcc, v77, v70
    v_lshrrev_b32 v78, 1, v78
    v_or_b32 v78, s37, v78
    v_cndmask_b32 v82, v82, v78, vcc
    v_med3_f32 v77, v71, s69, v76
    v_add_f32 v78, v71, v76
    v_cmp_neq_f32 vcc, v77, v71
    v_lshrrev_b32 v78, 1, v78
    v_or_b32 v78, s37, v78
    v_cndmask_b32 v83, v83, v78, vcc
.L0_3:
    v_add_u32 v80, 0x8000, v80
    v_add_u32 v81, 0x8000, v81
    v_add_u32 v82, 0x8000, v82
    v_add_u32 v83, 0x8000, v83
    v_add_u32 v72, 0x5480, v72
    v_add_u32 v73, 0x5480, v73
    v_add_u32 v74, 0x5480, v74
    v_add_u32 v75, 0x5480, v75
    v_lshrrev_b32 v76, 16, v72
    v_lshrrev_b32 v78, 16, v74
    v_sub_u32 v81, v81, v76
    v_sub_u32 v83, v83, v78
    v_perm_b32 v80, v72, v80, s39
    v_perm_b32 v81, v73, v81, s39
    v_perm_b32 v82, v74, v82, s39
    v_perm_b32 v83, v75, v83, s39
    ds_write_b128 v19, v[80:83] offset:0
    s_branch K1_TE
K1_TL:
    ds_read_b128 v[88:91], v87 offset:17408
    s_mov_b32 s33, 16384
    s_waitcnt lgkmcnt(0)
    buffer_store_dwordx4 v[88:91], v86, s[64:67], s33 offen sc1
K1_TE:
    s_waitcnt lgkmcnt(0)
    s_barrier
    s_cmp_ge_u32 s28, 8
    s_cbranch_scc1 K1_TF
    ds_read_b128 v[88:91], v87 offset:0
    s_mov_b32 s33, 32768
    s_waitcnt lgkmcnt(0)
    buffer_store_dwordx4 v[88:91], v86, s[64:67], s33 offen sc1
    s_branch K1_FIN
K1_TF:
    s_cmp_lg_u32 s28, 15
    s_cbranch_scc1 K1_FIN
    v_mov_b32 v20, 0
    ds_read_b32 v21, v20 offset:0
    s_and_b32 s33, s2, 7
    s_lshl4_add_u32 s33, s33, s75
    s_lshl_b32 s33, s33, 6
    s_add_u32 s33, s33, 18096128
    v_lshl_add_u32 v20, v0, 2, s33
    s_mov_b64 exec, 0xffff
    s_waitcnt lgkmcnt(0)
    global_store_dword v20, v21, s[26:27] sc1
    s_mov_b64 exec, -1
    s_branch K1_FIN
K1_SPARE:
    s_cmp_eq_u32 s2, 127
    s_cbranch_scc1 K1_SP1
    s_cmp_ge_u32 s28, 3
    s_cbranch_scc1 K1_END
    s_getpc_b64 s[72:73]
K1_PB:
    s_sub_u32 s72, s72, K1_PB-gcn_prep_kernel
    s_subb_u32 s73, s73, 0
    s_lshl_b32 s33, s28, 13
    v_lshl_add_u32 v94, v0, 7, s33
    v_min_u32 v94, K2_END-gcn_prep_kernel, v94
    global_load_dword v94, v94, s[72:73]
    s_endpgm
K1_SP1:
    s_and_b32 s35, s28, 1
    s_lshl_b32 s35, s35, 2
    v_bfe_u32 v84, v0, 4, 1
    v_lshl_or_b32 v84, v84, 1, s35
    v_xor_b32 v84, v84, v0
    v_and_b32 v84, 7, v84
    s_lshl_b32 s35, s28, 11
    s_mov_b32 s36, 0
    s_add_u32 s35, s35, s36
    v_lshl_add_u32 v82, v84, 4, s35
    v_lshrrev_b32 v84, 3, v0
    v_lshl_add_u32 v82, v84, 8, v82
    s_lshl_b32 s35, s28, 10
    s_add_u32 m0, s35, 256
    s_waitcnt lgkmcnt(0)
    global_load_lds_dwordx4 v82, s[12:13]
    s_add_u32 m0, s35, 16640
    s_nop 0
    global_load_lds_dwordx4 v82, s[18:19]
    v_add_u32 v83, 128, v82
    s_add_u32 m0, s35, 33024
    s_nop 0
    global_load_lds_dwordx4 v83, s[12:13]
    s_add_u32 m0, s35, 49408
    s_nop 0
    global_load_lds_dwordx4 v83, s[18:19]
    s_mov_b32 s38, 0xbfb8aa3b
    v_and_b32 v2, 15, v0
    v_lshlrev_b32 v3, 3, v2
    s_and_b32 s33, s28, 1
    s_lshl_b32 s33, s33, 7
    v_add_u32 v3, s33, v3
    v_lshrrev_b32 v4, 4, v0
    v_lshl_add_u32 v3, v4, 10, v3
    s_and_b32 s34, s28, 3
    s_cmp_ge_u32 s28, 2
    s_cbranch_scc1 K1_S1
    global_load_dwordx2 v[8:9], v3, s[16:17] offset:0
    global_load_dwordx2 v[10:11], v3, s[16:17] offset:256
    global_load_dwordx2 v[12:13], v3, s[16:17] offset:512
    global_load_dwordx2 v[14:15], v3, s[16:17] offset:768
K1_S1:
    v_and_b32 v84, 0x30, v0
    v_lshlrev_b32 v18, 6, v84
    v_and_b32 v84, 12, v0
    v_lshl_or_b32 v18, v84, 5, v18
    v_bfe_u32 v84, v0, 3, 2
    v_xor_b32 v84, s34, v84
    v_lshl_or_b32 v18, v84, 5, v18
    v_and_b32 v84, 3, v0
    v_lshl_or_b32 v18, v84, 3, v18
    v_add_u32 v18, 256, v18
    s_lshr_b32 s33, s28, 2
    s_lshl_b32 s33, s33, 14
    v_add_u32 v18, s33, v18
    s_lshl_b32 s33, s28, 12
    s_add_u32 s33, s33, 18120704
    v_lshl_add_u32 v7, v0, 4, s33
    v_mov_b64 v[56:57], 0
    v_mov_b64 v[58:59], 0
    s_lshl3_add_u32 s33, s28, 7
    s_lshl_b32 s33, s33, 10
    s_add_u32 s33, s33, 17825792
    v_lshl_add_u32 v3, v0, 4, s33
    s_waitcnt vmcnt(0)
    s_barrier
    ds_read_b64_tr_b16 v[64:65], v18 offset:0
    ds_read_b64_tr_b16 v[66:67], v18 offset:512
    ds_read_b64_tr_b16 v[68:69], v18 offset:4096
    ds_read_b64_tr_b16 v[70:71], v18 offset:4608
    ds_read_b64_tr_b16 v[72:73], v18 offset:8192
    ds_read_b64_tr_b16 v[74:75], v18 offset:8704
    ds_read_b64_tr_b16 v[76:77], v18 offset:12288
    ds_read_b64_tr_b16 v[78:79], v18 offset:12800
    s_cmp_lt_u32 s28, 13
    s_cbranch_scc1 K1_S2
    global_store_dwordx4 v3, v[56:59], s[26:27] sc1
K1_S2:
    s_waitcnt lgkmcnt(0)
    global_store_dwordx4 v7, v[64:67], s[26:27] offset:0 sc1
    global_store_dwordx4 v7, v[68:71], s[26:27] offset:1024 sc1
    global_store_dwordx4 v7, v[72:75], s[26:27] offset:2048 sc1
    global_store_dwordx4 v7, v[76:79], s[26:27] offset:3072 sc1
    s_cmp_ge_u32 s28, 2
    s_cbranch_scc1 K1_FIN
    s_mul_i32 s33, s28, 2560256
    s_add_u32 s33, s33, 2560000
    v_lshl_add_u32 v5, v0, 2, s33
    v_mov_b32 v6, 0x7f80
    global_store_dword v5, v6, s[26:27] sc1
    s_lshl_b32 s33, s28, 11
    s_add_u32 s33, s33, 18087936
    v_lshl_add_u32 v7, v0, 4, s33
    v_lshlrev_b32 v32, 16, v8
    v_and_b32 v33, 0xffff0000, v8
    v_lshlrev_b32 v34, 16, v9
    v_and_b32 v35, 0xffff0000, v9
    v_lshlrev_b32 v36, 16, v10
    v_and_b32 v37, 0xffff0000, v10
    v_lshlrev_b32 v38, 16, v11
    v_and_b32 v39, 0xffff0000, v11
    v_lshlrev_b32 v40, 16, v12
    v_and_b32 v41, 0xffff0000, v12
    v_lshlrev_b32 v42, 16, v13
    v_and_b32 v43, 0xffff0000, v13
    v_lshlrev_b32 v44, 16, v14
    v_and_b32 v45, 0xffff0000, v14
    v_lshlrev_b32 v46, 16, v15
    v_and_b32 v47, 0xffff0000, v15
    v_mul_f32 v32, s38, v32
    v_mul_f32 v33, s38, v33
    v_mul_f32 v34, s38, v34
    v_mul_f32 v35, s38, v35
    v_mul_f32 v36, s38, v36
    v_mul_f32 v37, s38, v37
    v_mul_f32 v38, s38, v38
    v_mul_f32 v39, s38, v39
    v_mul_f32 v40, s38, v40
    v_mul_f32 v41, s38, v41
    v_mul_f32 v42, s38, v42
    v_mul_f32 v43, s38, v43
    v_mul_f32 v44, s38, v44
    v_mul_f32 v45, s38, v45
    v_mul_f32 v46, s38, v46
    v_mul_f32 v47, s38, v47
    v_cvt_pk_bf16_f32 v48, v32, v36
    v_cvt_pk_bf16_f32 v49, v40, v44
    v_cvt_pk_bf16_f32 v50, v33, v37
    v_cvt_pk_bf16_f32 v51, v41, v45
    v_cvt_pk_bf16_f32 v52, v34, v38
    v_cvt_pk_bf16_f32 v53, v42, v46
    v_cvt_pk_bf16_f32 v54, v35, v39
    v_cvt_pk_bf16_f32 v55, v43, v47
    global_store_dwordx4 v7, v[48:51], s[26:27] offset:0 sc1
    global_store_dwordx4 v7, v[52:55], s[26:27] offset:1024 sc1
    s_branch K1_FIN
K1_END:
    s_endpgm
.globl gcn_main_kernel
.p2align 8
.type gcn_main_kernel,@function
gcn_main_kernel:
    s_cmp_ge_u32 s2, 256
    s_cbranch_scc1 K2_END
    s_load_dwordx16 s[4:19], s[0:1], 0
    s_load_dwordx8 s[20:27], s[0:1], 64
    v_lshrrev_b32 v2, 6, v0
    v_and_b32 v0, 63, v0
    v_readfirstlane_b32 s28, v2
    s_and_b32 s30, s2, 3
    s_lshl_b32 s30, s30, 5
    s_lshr_b32 s33, s2, 3
    s_add_u32 s30, s30, s33
    s_bfe_u32 s29, s2, 0x10002
    s_setprio 2
    s_lshl_b32 s33, s28, 10
    s_add_u32 s33, s33, s30
    s_lshl3_add_u32 s33, s33, 17829888
    v_lshrrev_b32 v124, 5, v0
    v_lshl_add_u32 v125, v124, 10, s33
    s_sub_u32 s33, s28, 4
    s_cmp_ge_u32 s33, 8
    s_cbranch_scc1 K2_PF
    s_lshl_b32 s33, s33, 10
    v_lshl_add_u32 v60, v0, 4, s33
    v_mov_b32 v64, 0x27100ba7
    v_mov_b32 v65, v64
    v_mov_b64 v[66:67], v[64:65]
    ds_write_b128 v60, v[64:67] offset:46592
    ds_write_b128 v60, v[64:67] offset:54784
    ds_write_b128 v60, v[64:67] offset:60160
    s_cmp_ge_u32 s28, 8
    s_cbranch_scc1 K2_PF
    v_mov_b64 v[68:69], 0
    v_mov_b64 v[70:71], 0
    v_min_u32 v61, 2288, v60
    ds_write_b128 v61, v[68:71]
    v_and_b32 v62, 16, v60
    v_add_u32 v62, 163808, v62
    ds_write_b128 v62, v[68:71]
K2_PF:
    s_waitcnt lgkmcnt(0)
    global_load_dwordx2 v[64:65], v125, s[26:27] offset:-4096
    global_load_dwordx2 v[66:67], v125, s[26:27] offset:-2048
    global_load_dwordx2 v[68:69], v125, s[26:27] offset:0
    global_load_dwordx2 v[70:71], v125, s[26:27] offset:2048
    s_barrier
    v_and_b32 v57, 31, v0
    s_add_u32 s60, s26, 15728640
    s_addc_u32 s61, s27, 0
    s_add_u32 s48, s26, 5242880
    s_addc_u32 s49, s27, 0
    s_mov_b32 s50, 10240000
    s_mov_b32 s51, 0x20000
    s_lshl_b32 s62, s28, 10
    s_add_u32 s62, s62, 4352
    v_lshrrev_b32 v126, 1, v0
    v_lshl_add_u32 v126, v126, 2, s62
    v_and_b32 v127, 1, v0
    v_lshlrev_b32 v127, 4, v127
    s_mov_b32 s52, 0
    s_mov_b32 s88, 0
    s_waitcnt vmcnt(0)
    v_cmp_lt_u32 s[64:65], v57, v65
    v_cmp_lt_u32 s[66:67], v57, v67
    v_cmp_lt_u32 s[68:69], v57, v69
    v_cmp_lt_u32 s[70:71], v57, v71
    v_lshl_add_u32 v18, v57, 2, v64
    v_lshl_add_u32 v19, v57, 2, v66
    v_lshl_add_u32 v20, v57, 2, v68
    v_lshl_add_u32 v21, v57, 2, v70
    v_max3_u32 v125, v65, v67, v69
    v_max_u32 v125, v125, v71
    s_mov_b64 exec, s[64:65]
    global_load_dword v26, v18, s[60:61]
    s_mov_b64 exec, s[66:67]
    global_load_dword v27, v19, s[60:61]
    s_mov_b64 exec, s[68:69]
    global_load_dword v28, v20, s[60:61]
    s_mov_b64 exec, s[70:71]
    global_load_dword v29, v21, s[60:61]
    s_mov_b64 exec, -1
    v_cmp_lt_u32 vcc, 32, v125
    s_bcnt1_i32_b64 s33, s[64:65]
    s_add_u32 s53, s52, s33
    s_bcnt1_i32_b64 s33, s[66:67]
    s_add_u32 s54, s53, s33
    s_bcnt1_i32_b64 s33, s[68:69]
    s_add_u32 s55, s54, s33
    s_bcnt1_i32_b64 s33, s[70:71]
    s_add_u32 s56, s55, s33
    s_mov_b32 s63, s56
    s_cbranch_vccnz K2_OV
K2_NOU1:
    s_mul_i32 s31, s30, 5120290
    s_add_u32 s31, s31, 65535
    s_lshr_b32 s31, s31, 16
    s_mov_b32 s40, s4
    s_mov_b32 s41, s5
    s_mov_b32 s42, 2560000
    s_mov_b32 s43, 0x20000
    s_and_b32 s34, s28, 3
    s_bitcmp1_b32 0xf80f, s28
    s_cbranch_scc1 K2_R0
K2_RD:
    s_setprio 0
    s_add_u32 s34, s63, 31
    s_and_b32 s34, s34, 0xffe0
    v_mov_b32 v124, s34
    v_mov_b32 v125, 0
    s_mov_b64 exec, 1
    ds_add_rtn_u32 v124, v125, v124 offset:2188
    s_cmp_gt_u32 s63, 256
    s_cbranch_scc1 K2_ST_w
    s_mov_b64 exec, s[64:65]
    s_lshl2_add_u32 s33, s52, s62
    v_mbcnt_lo_u32_b32 v108, exec_lo, 0
    v_mbcnt_hi_u32_b32 v108, exec_hi, v108
    v_lshl_add_u32 v44, v108, 2, s33
    ds_write_b32 v44, v18
    s_mov_b64 exec, s[66:67]
    s_lshl2_add_u32 s33, s53, s62
    v_mbcnt_lo_u32_b32 v109, exec_lo, 0
    v_mbcnt_hi_u32_b32 v109, exec_hi, v109
    v_lshl_add_u32 v45, v109, 2, s33
    ds_write_b32 v45, v19
    s_mov_b64 exec, s[68:69]
    s_lshl2_add_u32 s33, s54, s62
    v_mbcnt_lo_u32_b32 v110, exec_lo, 0
    v_mbcnt_hi_u32_b32 v110, exec_hi, v110
    v_lshl_add_u32 v46, v110, 2, s33
    ds_write_b32 v46, v20
    s_mov_b64 exec, s[70:71]
    s_lshl2_add_u32 s33, s55, s62
    v_mbcnt_lo_u32_b32 v111, exec_lo, 0
    v_mbcnt_hi_u32_b32 v111, exec_hi, v111
    v_lshl_add_u32 v47, v111, 2, s33
    ds_write_b32 v47, v21
    s_cmp_eq_u32 s88, 0
    s_cbranch_scc1 K2_ST_w
    s_mov_b64 exec, s[72:73]
    s_lshl2_add_u32 s33, s56, s62
    v_mbcnt_lo_u32_b32 v112, exec_lo, 0
    v_mbcnt_hi_u32_b32 v112, exec_hi, v112
    v_lshl_add_u32 v48, v112, 2, s33
    ds_write_b32 v48, v22
K2_ST_w:
    s_mov_b64 exec, -1
    ds_read2_b32 v[60:61], v126 offset0:0 offset1:32
    ds_read2_b32 v[62:63], v126 offset0:64 offset1:96
    ds_read2_b32 v[64:65], v126 offset0:128 offset1:160
    ds_read2_b32 v[66:67], v126 offset0:192 offset1:224
    s_cmp_gt_u32 s63, 256
    s_cselect_b32 s35, 0x10000, s34
    s_lshr_b32 s63, s34, 5
    s_waitcnt lgkmcnt(2)
    v_readfirstlane_b32 s36, v124
    s_add_u32 s35, s35, s36
    s_cmp_le_u32 s35, 2976
    s_cbranch_scc1 K2_ST_ok
    v_mov_b32 v124, 1
    ds_write_b32 v125, v124 offset:2176
    s_mov_b32 s63, 0
K2_ST_ok:
    s_lshl_b32 s39, s36, 5
    s_add_u32 s39, s39, 68352
    s_cmp_gt_u32 s63, 0
    s_cselect_b64 exec, -1, 0
    s_add_u32 m0, s39, 0
    v_lshl_add_u32 v60, v60, 3, v127
    buffer_load_dwordx4 v60, s[48:51], 0 offen  lds
    s_cmp_gt_u32 s63, 1
    s_cselect_b64 exec, -1, 0
    s_add_u32 m0, s39, 1024
    v_lshl_add_u32 v61, v61, 3, v127
    buffer_load_dwordx4 v61, s[48:51], 0 offen  lds
    s_mov_b64 exec, -1
    s_add_u32 s33, s52, s36
    v_add_u32 v108, s33, v108
    s_add_u32 s33, s53, s36
    v_add_u32 v109, s33, v109
    s_add_u32 s33, s54, s36
    v_add_u32 v110, s33, v110
    s_add_u32 s33, s55, s36
    v_add_u32 v111, s33, v111
    v_and_b32 v57, 15, v0
    v_lshlrev_b32 v3, 4, v57
    v_mov_b32 v5, v3
    v_mov_b32 v7, v3
    v_mov_b32 v9, v3
    v_lshlrev_b32 v35, 2, v57
    v_lshrrev_b32 v11, 1, v0
    v_and_b32 v11, 24, v11
    v_add_u32 v11, 68352, v11
    s_movk_i32 s83, 272
    s_mov_b32 s84, 0xffff0000
    s_mov_b32 s82, 0
    s_mov_b32 s24, 0
    v_mov_b32 v124, 4
    s_mov_b32 s78, s36
    s_mov_b32 s79, s56
    s_cmp_ge_u32 s28, 8
    s_cselect_b32 s34, 0x4080605, 0
    s_cselect_b32 s35, 0xb09070a, 0
    s_cselect_b32 s36, 0, 0xd0c0e12
    s_cselect_b32 s37, 0, 0x2010300
    s_or_b64 s[34:35], s[34:35], s[36:37]
    s_lshl_b32 s33, s28, 3
    s_lshr_b64 s[34:35], s[34:35], s33
    s_and_b32 s90, s34, 31
    s_lshr_b32 s94, 0x10110f13, s33
    s_and_b32 s94, s94, 31
    s_cmp_lt_u32 s28, 4
    s_cselect_b32 s91, 2, 1
    s_mul_i32 s33, s29, 2560256
    s_add_u32 s44, s26, s33
    s_addc_u32 s45, s27, 0
    s_or_b32 s45, s45, 0x01000000
    s_mov_b32 s46, 2560256
    s_mov_b32 s47, 0x20000
    s_mov_b32 s100, 0x498637bd
    s_mov_b32 s101, 0x498637bd
    s_movk_i32 s95, 0x3f80
    s_mov_b32 s92, 0x3f800000
    s_mov_b32 s52, s22
    s_mov_b32 s53, s23
    s_mov_b32 s54, 2560000
    s_mov_b32 s55, 0x20000
    s_waitcnt lgkmcnt(0)
    s_cmp_ge_u32 s28, 12
    s_cbranch_scc1 K2_Wa
    s_cmp_ge_u32 s28, 4
    s_cbranch_scc1 K2_Wb
    s_waitcnt vmcnt(8)
    s_branch K2_Wc
K2_Wa:
    s_waitcnt vmcnt(10)
    s_branch K2_Wc
K2_Wb:
    s_waitcnt vmcnt(2)
K2_Wc:
    s_mov_b64 exec, s[64:65]
    v_and_b32 v44, 0x7fc, v26
    ds_add_rtn_u32 v36, v44, v124 offset:0
    s_mov_b64 exec, s[66:67]
    v_and_b32 v45, 0x7fc, v27
    ds_add_rtn_u32 v37, v45, v124 offset:0
    s_mov_b64 exec, s[68:69]
    v_and_b32 v46, 0x7fc, v28
    ds_add_rtn_u32 v38, v46, v124 offset:0
    s_mov_b64 exec, s[70:71]
    v_and_b32 v47, 0x7fc, v29
    ds_add_rtn_u32 v39, v47, v124 offset:0
    s_cmp_eq_u32 s88, 0
    s_cbranch_scc1 K2_A1
    s_mov_b64 exec, s[72:73]
    v_and_b32 v48, 0x7fc, v30
    ds_add_rtn_u32 v40, v48, v124 offset:0
    s_add_u32 s33, s78, s79
    v_add_u32 v112, s33, v112
    s_waitcnt lgkmcnt(0)
    v_and_b32 v125, 0x7f0, v30
    v_and_or_b32 v112, v30, s84, v112
    v_mad_u32_u24 v40, v125, 17, v40
K2_A1:
    s_mov_b64 exec, -1
    s_waitcnt lgkmcnt(0)
    v_and_b32 v125, 0x7f0, v26
    v_and_or_b32 v108, v26, s84, v108
    v_mad_u32_u24 v36, v125, 17, v36
    v_and_b32 v125, 0x7f0, v27
    v_and_or_b32 v109, v27, s84, v109
    v_mad_u32_u24 v37, v125, 17, v37
    v_and_b32 v125, 0x7f0, v28
    v_and_or_b32 v110, v28, s84, v110
    v_mad_u32_u24 v38, v125, 17, v38
    v_and_b32 v125, 0x7f0, v29
    v_and_or_b32 v111, v29, s84, v111
    v_mad_u32_u24 v39, v125, 17, v39
    s_sub_u32 s33, s28, 4
    s_cmp_lt_u32 s33, 8
    s_cbranch_scc1 K2_B1
    s_waitcnt vmcnt(2)
K2_B1:
    s_barrier
    s_cmp_ge_u32 s28, 11
    s_cbranch_scc1 K2_PW
K2_B15:
    s_barrier
    s_cmp_lg_u32 s82, 0
    s_cbranch_scc1 K2_SSC
    s_bitcmp1_b32 0xfff, s28
    s_cbranch_scc0 K2_RF
    s_cmp_le_u32 s63, 2
    s_cbranch_scc1 K2_RF1
    s_add_u32 m0, s39, 2048
    v_lshl_add_u32 v62, v62, 3, v127
    buffer_load_dwordx4 v62, s[48:51], 0 offen  lds
    s_cmp_le_u32 s63, 3
    s_cbranch_scc1 K2_RF1
    s_add_u32 m0, s39, 3072
    v_lshl_add_u32 v63, v63, 3, v127
    buffer_load_dwordx4 v63, s[48:51], 0 offen  lds
    s_cmp_le_u32 s63, 4
    s_cbranch_scc1 K2_RF1
    s_add_u32 m0, s39, 4096
    v_lshl_add_u32 v64, v64, 3, v127
    buffer_load_dwordx4 v64, s[48:51], 0 offen  lds
    s_cmp_le_u32 s63, 5
    s_cbranch_scc1 K2_RF1
    s_add_u32 m0, s39, 5120
    v_lshl_add_u32 v65, v65, 3, v127
    buffer_load_dwordx4 v65, s[48:51], 0 offen  lds
    s_cmp_le_u32 s63, 6
    s_cbranch_scc1 K2_RF1
    s_add_u32 m0, s39, 6144
    v_lshl_add_u32 v66, v66, 3, v127
    buffer_load_dwordx4 v66, s[48:51], 0 offen  lds
    s_cmp_le_u32 s63, 7
    s_cbranch_scc1 K2_RF1
    s_add_u32 m0, s39, 7168
    v_lshl_add_u32 v67, v67, 3, v127
    buffer_load_dwordx4 v67, s[48:51], 0 offen  lds
K2_RF1:
    s_mov_b32 s63, 0
K2_RF:
    s_mov_b64 exec, s[64:65]
    ds_read_b32 v44, v44 offset:0
    s_mov_b64 exec, s[66:67]
    ds_read_b32 v45, v45 offset:0
    s_mov_b64 exec, s[68:69]
    ds_read_b32 v46, v46 offset:0
    s_mov_b64 exec, s[70:71]
    ds_read_b32 v47, v47 offset:0
    s_cmp_eq_u32 s88, 0
    s_cbranch_scc1 K2_A2
    s_mov_b64 exec, s[72:73]
    ds_read_b32 v48, v48 offset:0
    s_waitcnt lgkmcnt(0)
    v_add_u32 v40, v40, v48
    ds_write_b32 v40, v112 offset:46592
K2_A2:
    s_waitcnt lgkmcnt(0)
    s_mov_b64 exec, s[64:65]
    v_add_u32 v36, v36, v44
    ds_write_b32 v36, v108 offset:46592
    s_mov_b64 exec, s[66:67]
    v_add_u32 v37, v37, v45
    ds_write_b32 v37, v109 offset:46592
    s_mov_b64 exec, s[68:69]
    v_add_u32 v38, v38, v46
    ds_write_b32 v38, v110 offset:46592
    s_mov_b64 exec, s[70:71]
    v_add_u32 v39, v39, v47
    ds_write_b32 v39, v111 offset:46592
K2_SCD:
    s_mov_b64 exec, -1
    s_cmp_eq_u32 s28, 11
    s_cbranch_scc1 K2_RANK
K2_RKD:
    s_cmp_lg_u32 s82, 0
    s_cbranch_scc1 K2_GD
    s_cmp_ge_u32 s28, 12
    s_cbranch_scc1 K2_GE
K2_GM:
    s_cmp_le_u32 s63, 2
    s_cbranch_scc1 K2_GD
    s_add_u32 m0, s39, 2048
    v_lshl_add_u32 v62, v62, 3, v127
    buffer_load_dwordx4 v62, s[48:51], 0 offen  lds
    s_cmp_le_u32 s63, 3
    s_cbranch_scc1 K2_GD
    s_add_u32 m0, s39, 3072
    v_lshl_add_u32 v63, v63, 3, v127
    buffer_load_dwordx4 v63, s[48:51], 0 offen  lds
    s_cmp_le_u32 s63, 4
    s_cbranch_scc1 K2_GD
    s_add_u32 m0, s39, 4096
    v_lshl_add_u32 v64, v64, 3, v127
    buffer_load_dwordx4 v64, s[48:51], 0 offen  lds
    s_cmp_le_u32 s63, 5
    s_cbranch_scc1 K2_GD
    s_add_u32 m0, s39, 5120
    v_lshl_add_u32 v65, v65, 3, v127
    buffer_load_dwordx4 v65, s[48:51], 0 offen  lds
    s_cmp_le_u32 s63, 6
    s_cbranch_scc1 K2_GD
    s_add_u32 m0, s39, 6144
    v_lshl_add_u32 v66, v66, 3, v127
    buffer_load_dwordx4 v66, s[48:51], 0 offen  lds
    s_cmp_le_u32 s63, 7
    s_cbranch_scc1 K2_GD
    s_add_u32 m0, s39, 7168
    v_lshl_add_u32 v67, v67, 3, v127
    buffer_load_dwordx4 v67, s[48:51], 0 offen  lds
K2_GD:
K2_GD1:
    v_lshlrev_b32 v24, 4, v0
    ds_read_b128 v[108:111], v24 offset:2304
    ds_read_b128 v[112:115], v24 offset:3328
    v_mov_b32 v34, 0x2b800000
    v_mov_b32 v30, 0
    s_lshl_b32 s33, s90, 5
    v_lshrrev_b32 v22, 4, v0
    v_lshl_add_u32 v22, v22, 3, s33
    v_and_b32 v23, 12, v0
    v_lshl_add_u32 v23, v23, 1, s33
    s_waitcnt lgkmcnt(0)
    s_barrier
    ds_read_b96 v[116:118], v30 offset:2176
    ds_read_b64 v[40:41], v22 offset:1536
    ds_read_u16 v13, v23 offset:1536
    s_waitcnt lgkmcnt(2)
    v_readfirstlane_b32 s33, v116
    v_readfirstlane_b32 s89, v117
    v_readfirstlane_b32 s34, v118
    s_or_b32 s24, s24, s34
    s_cmp_lg_u32 s82, 0
    s_cbranch_scc1 K2_SLOWDEC
    s_mov_b32 s80, 0
    s_mov_b32 s81, 1
    s_or_b32 s34, s33, s89
    s_cbranch_scc1 K2_SLOWINIT
K2_GO:
    s_setprio 3
    v_and_b32 v22, 3, v0
    s_waitcnt lgkmcnt(0)
    v_and_b32 v12, 0xffff, v40
    v_lshl_add_u32 v13, v22, 2, v13
    v_readfirstlane_b32 s93, v40
    ds_read_u16 v2, v12 offset:46594
    ds_read_u16 v4, v12 offset:46598
    ds_read_u16 v6, v12 offset:46602
    ds_read_u16 v8, v12 offset:46606
    ds_read_u16 v10, v13 offset:46592
    v_add_u32 v42, v12, v35
    v_lshl_add_u32 v41, v35, 1, v41
    s_lshr_b32 s93, s93, 24
    s_add_u32 s96, s93, 1
    s_lshr_b32 s96, s96, 1
    s_cmp_lg_u32 s24, 0
    s_cbranch_scc1 K2_XGF
    s_cmp_lg_u32 s80, 0
    s_cbranch_scc1 K2_H1
    s_cmp_le_u32 s96, 2
    s_cbranch_scc1 K2_H1
    s_cmp_ge_u32 s28, 4
    s_cbranch_scc1 K2_H2
    s_waitcnt lgkmcnt(1)
    buffer_load_dwordx4 v[44:47], v[2:3], s[44:47], 0 idxen offen
    buffer_load_dwordx4 v[48:51], v[4:5], s[44:47], 0 idxen offen
    buffer_load_dwordx4 v[52:55], v[6:7], s[44:47], 0 idxen offen
    buffer_load_dwordx4 v[56:59], v[8:9], s[44:47], 0 idxen offen
    ds_read_u16_d16_hi v92, v42 offset:4352
    ds_read_u16_d16_hi v93, v42 offset:4352
    ds_read_u16_d16_hi v94, v42 offset:4352
    ds_read_u16_d16_hi v95, v42 offset:4352
    ds_read_u16_d16_hi v96, v42 offset:4416
    ds_read_u16_d16_hi v97, v42 offset:4416
    ds_read_u16_d16_hi v98, v42 offset:4416
    ds_read_u16_d16_hi v99, v42 offset:4416
    s_waitcnt lgkmcnt(4)
    ds_read_u16_d16_hi v100, v42 offset:4480
    ds_read_u16_d16_hi v101, v42 offset:4480
    ds_read_u16_d16_hi v102, v42 offset:4480
    ds_read_u16_d16_hi v103, v42 offset:4480
    ds_read_u16_d16_hi v104, v42 offset:4544
    ds_read_u16_d16_hi v105, v42 offset:4544
    ds_read_u16_d16_hi v106, v42 offset:4544
    ds_read_u16_d16_hi v107, v42 offset:4544
    v_lshl_add_u32 v43, v10, 5, v11
    s_waitcnt vmcnt(4)
    s_barrier
    s_branch K2_H3
K2_H1:
    s_waitcnt vmcnt(0)
    s_barrier
    s_branch K2_G1
K2_H2:
    s_waitcnt vmcnt(0)
    s_barrier
    s_waitcnt lgkmcnt(0)
    buffer_load_dwordx4 v[44:47], v[2:3], s[44:47], 0 idxen offen
    buffer_load_dwordx4 v[48:51], v[4:5], s[44:47], 0 idxen offen
    buffer_load_dwordx4 v[52:55], v[6:7], s[44:47], 0 idxen offen
    buffer_load_dwordx4 v[56:59], v[8:9], s[44:47], 0 idxen offen
    ds_read_u16_d16_hi v92, v42 offset:4352
    ds_read_u16_d16_hi v93, v42 offset:4352
    ds_read_u16_d16_hi v94, v42 offset:4352
    ds_read_u16_d16_hi v95, v42 offset:4352
    ds_read_u16_d16_hi v96, v42 offset:4416
    ds_read_u16_d16_hi v97, v42 offset:4416
    ds_read_u16_d16_hi v98, v42 offset:4416
    ds_read_u16_d16_hi v99, v42 offset:4416
    s_waitcnt lgkmcnt(4)
    ds_read_u16_d16_hi v100, v42 offset:4480
    ds_read_u16_d16_hi v101, v42 offset:4480
    ds_read_u16_d16_hi v102, v42 offset:4480
    ds_read_u16_d16_hi v103, v42 offset:4480
    ds_read_u16_d16_hi v104, v42 offset:4544
    ds_read_u16_d16_hi v105, v42 offset:4544
    ds_read_u16_d16_hi v106, v42 offset:4544
    ds_read_u16_d16_hi v107, v42 offset:4544
    v_lshl_add_u32 v43, v10, 5, v11
K2_H3:
    ds_read_b64 v[36:37], v43
    ds_read_u16 v10, v13 offset:46608
    ds_read_u16 v2, v12 offset:46610
    ds_read_u16 v4, v12 offset:46614
    ds_read_u16 v6, v12 offset:46618
    ds_read_u16 v8, v12 offset:46622
    s_cmp_eq_u32 s91, 1
    s_cselect_b32 s97, 4, 0
    v_mov_b64 v[14:15], s[100:101]
    v_mov_b64 v[16:17], s[100:101]
    v_mov_b64 v[18:19], 0
    v_mov_b64 v[20:21], 0
    v_add_u32 v12, 48, v12
    v_add_u32 v13, 48, v13
    s_waitcnt lgkmcnt(4)
    v_mfma_f32_16x16x16_bf16 v[76:79], v[36:37], v[108:109], v[92:95]
    v_mfma_f32_16x16x16_bf16 v[80:83], v[36:37], v[110:111], v[96:99]
    v_mfma_f32_16x16x16_bf16 v[84:87], v[36:37], v[112:113], v[100:103]
    v_mfma_f32_16x16x16_bf16 v[88:91], v[36:37], v[114:115], v[104:107]
    v_lshl_add_u32 v43, v10, 5, v11
    ds_read_b64 v[36:37], v43
    ds_read_u16 v10, v13 offset:46576
.p2align 3
K2_N0:
    s_nop 3
    v_exp_f32 v22, v76
    v_exp_f32 v26, v77
    v_exp_f32 v23, v80
    v_exp_f32 v27, v81
    v_exp_f32 v24, v84
    v_exp_f32 v28, v85
    v_exp_f32 v25, v88
    v_exp_f32 v29, v89
    s_waitcnt vmcnt(2)
    v_lshlrev_b64 v[120:121], 16, v[44:45]
    v_lshlrev_b64 v[124:125], 16, v[48:49]
    v_lshlrev_b64 v[122:123], 16, v[46:47]
    v_lshlrev_b64 v[126:127], 16, v[50:51]
    v_pk_fma_f32 v[22:23], v[22:23], v[120:121], v[34:35] op_sel_hi:[1,1,0] clamp
    v_pk_fma_f32 v[26:27], v[26:27], v[124:125], v[34:35] op_sel_hi:[1,1,0] clamp
    v_pk_fma_f32 v[24:25], v[24:25], v[122:123], v[34:35] op_sel_hi:[1,1,0] clamp
    v_pk_fma_f32 v[28:29], v[28:29], v[126:127], v[34:35] op_sel_hi:[1,1,0] clamp
    v_pk_mul_f32 v[30:31], v[22:23], v[26:27]
    v_pk_mul_f32 v[32:33], v[24:25], v[28:29]
    v_pk_mul_f32 v[116:117], v[44:45], v[26:27]
    v_pk_mul_f32 v[118:119], v[46:47], v[28:29]
    v_pk_fma_f32 v[116:117], v[48:49], v[22:23], v[116:117]
    v_pk_fma_f32 v[118:119], v[50:51], v[24:25], v[118:119]
    v_rcp_f32 v30, v30
    v_rcp_f32 v31, v31
    v_rcp_f32 v32, v32
    v_rcp_f32_e64 v33, v33
    s_waitcnt lgkmcnt(0)
    buffer_load_dwordx4 v[60:63], v[2:3], s[44:47], 0 idxen offen
    buffer_load_dwordx4 v[64:67], v[4:5], s[44:47], 0 idxen offen
    buffer_load_dwordx4 v[68:71], v[6:7], s[44:47], 0 idxen offen
    buffer_load_dwordx4 v[72:75], v[8:9], s[44:47], 0 idxen offen
    buffer_load_dwordx2 v[38:39], v41, s[40:43], 0 offen
    ds_read_u16 v2, v12 offset:46578
    ds_read_u16 v4, v12 offset:46582
    ds_read_u16 v6, v12 offset:46586
    ds_read_u16 v8, v12 offset:46590
    v_pk_add_f32 v[22:23], v[22:23], v[26:27]
    v_pk_add_f32 v[24:25], v[24:25], v[28:29]
    v_pk_fma_f32 v[18:19], v[116:117], v[30:31], v[18:19]
    v_pk_fma_f32 v[20:21], v[118:119], v[32:33], v[20:21]
    v_pk_fma_f32 v[14:15], v[22:23], v[30:31], v[14:15]
    v_pk_fma_f32 v[16:17], v[24:25], v[32:33], v[16:17]
    v_exp_f32 v22, v78
    v_exp_f32 v26, v79
    v_exp_f32_e64 v23, v82
    v_mfma_f32_16x16x16_bf16 v[76:79], v[36:37], v[108:109], v[92:95]
    v_exp_f32 v27, v83
    v_exp_f32 v24, v86
    v_mfma_f32_16x16x16_bf16 v[80:83], v[36:37], v[110:111], v[96:99]
    v_exp_f32 v28, v87
    v_exp_f32 v25, v90
    v_mfma_f32_16x16x16_bf16 v[84:87], v[36:37], v[112:113], v[100:103]
    v_exp_f32 v29, v91
    s_waitcnt vmcnt(5)
    v_lshlrev_b64 v[120:121], 16, v[52:53]
    v_lshlrev_b64 v[124:125], 16, v[56:57]
    v_lshlrev_b64 v[122:123], 16, v[54:55]
    v_lshlrev_b64 v[126:127], 16, v[58:59]
    v_pk_fma_f32 v[22:23], v[22:23], v[120:121], v[34:35] op_sel_hi:[1,1,0] clamp
    v_pk_fma_f32 v[26:27], v[26:27], v[124:125], v[34:35] op_sel_hi:[1,1,0] clamp
    v_pk_fma_f32 v[24:25], v[24:25], v[122:123], v[34:35] op_sel_hi:[1,1,0] clamp
    v_pk_fma_f32 v[28:29], v[28:29], v[126:127], v[34:35] op_sel_hi:[1,1,0] clamp
    v_pk_mul_f32 v[30:31], v[22:23], v[26:27]
    v_pk_mul_f32 v[32:33], v[24:25], v[28:29]
    v_pk_mul_f32 v[116:117], v[52:53], v[26:27]
    v_pk_mul_f32 v[118:119], v[54:55], v[28:29]
    v_pk_fma_f32 v[116:117], v[56:57], v[22:23], v[116:117]
    v_pk_fma_f32 v[118:119], v[58:59], v[24:25], v[118:119]
    v_mfma_f32_16x16x16_bf16 v[88:91], v[36:37], v[114:115], v[104:107]
    v_rcp_f32 v30, v30
    v_rcp_f32 v31, v31
    v_rcp_f32 v32, v32
    v_rcp_f32_e64 v33, v33
    s_waitcnt lgkmcnt(0)
    buffer_load_dwordx4 v[44:47], v[2:3], s[44:47], 0 idxen offen
    buffer_load_dwordx4 v[48:51], v[4:5], s[44:47], 0 idxen offen
    buffer_load_dwordx4 v[52:55], v[6:7], s[44:47], 0 idxen offen
    buffer_load_dwordx4 v[56:59], v[8:9], s[44:47], 0 idxen offen
    ds_read_u16 v2, v12 offset:46594
    ds_read_u16 v4, v12 offset:46598
    ds_read_u16 v6, v12 offset:46602
    ds_read_u16 v8, v12 offset:46606
    v_lshl_add_u32 v43, v10, 5, v11
    ds_read_b64 v[36:37], v43
    ds_read_u16 v10, v13 offset:46592
    v_pk_add_f32 v[22:23], v[22:23], v[26:27]
    v_pk_add_f32 v[24:25], v[24:25], v[28:29]
    v_pk_fma_f32 v[18:19], v[116:117], v[30:31], v[18:19]
    v_pk_fma_f32 v[20:21], v[118:119], v[32:33], v[20:21]
    v_pk_fma_f32 v[14:15], v[22:23], v[30:31], v[14:15]
    v_pk_fma_f32 v[16:17], v[24:25], v[32:33], v[16:17]
    s_sub_u32 s96, s96, 1
    s_cmp_eq_u32 s96, 2
    s_cbranch_scc1 K2_PB
    s_branch K2_NB
K2_GROUP:
    s_lshl_b32 s33, s90, 5
    v_lshrrev_b32 v22, 4, v0
    v_lshl_add_u32 v22, v22, 3, s33
    v_and_b32 v23, 12, v0
    v_lshl_add_u32 v23, v23, 1, s33
    ds_read_b64 v[40:41], v22 offset:1536
    ds_read_u16 v13, v23 offset:1536
K2_G0:
    v_and_b32 v22, 3, v0
    s_waitcnt lgkmcnt(0)
    v_and_b32 v12, 0xffff, v40
    v_lshl_add_u32 v13, v22, 2, v13
    v_readfirstlane_b32 s93, v40
    ds_read_u16 v2, v12 offset:46594
    ds_read_u16 v4, v12 offset:46598
    ds_read_u16 v6, v12 offset:46602
    ds_read_u16 v8, v12 offset:46606
    ds_read_u16 v10, v13 offset:46592
    v_add_u32 v42, v12, v35
    v_lshl_add_u32 v41, v35, 1, v41
    s_lshr_b32 s93, s93, 24
    s_add_u32 s96, s93, 1
    s_lshr_b32 s96, s96, 1
    s_cmp_lg_u32 s24, 0
    s_cbranch_scc1 K2_XG
K2_G1:
    s_waitcnt lgkmcnt(1)
    buffer_load_dwordx4 v[44:47], v[2:3], s[44:47], 0 idxen offen
    buffer_load_dwordx4 v[48:51], v[4:5], s[44:47], 0 idxen offen
    buffer_load_dwordx4 v[52:55], v[6:7], s[44:47], 0 idxen offen
    buffer_load_dwordx4 v[56:59], v[8:9], s[44:47], 0 idxen offen
    ds_read_u16 v2, v12 offset:46610
    ds_read_u16 v4, v12 offset:46614
    ds_read_u16 v6, v12 offset:46618
    ds_read_u16 v8, v12 offset:46622
    s_waitcnt lgkmcnt(4)
    v_lshl_add_u32 v43, v10, 5, v11
    ds_read_b64 v[36:37], v43
    ds_read_u16 v10, v13 offset:46608
    s_waitcnt lgkmcnt(2)
    buffer_load_dwordx4 v[60:63], v[2:3], s[44:47], 0 idxen offen
    buffer_load_dwordx4 v[64:67], v[4:5], s[44:47], 0 idxen offen
    buffer_load_dwordx4 v[68:71], v[6:7], s[44:47], 0 idxen offen
    buffer_load_dwordx4 v[72:75], v[8:9], s[44:47], 0 idxen offen
    buffer_load_dwordx2 v[38:39], v41, s[40:43], 0 offen
    ds_read_u16_d16_hi v92, v42 offset:4352
    ds_read_u16_d16_hi v93, v42 offset:4352
    ds_read_u16_d16_hi v94, v42 offset:4352
    ds_read_u16_d16_hi v95, v42 offset:4352
    ds_read_u16_d16_hi v96, v42 offset:4416
    ds_read_u16_d16_hi v97, v42 offset:4416
    ds_read_u16_d16_hi v98, v42 offset:4416
    ds_read_u16_d16_hi v99, v42 offset:4416
    s_waitcnt lgkmcnt(4)
    ds_read_u16_d16_hi v100, v42 offset:4480
    ds_read_u16_d16_hi v101, v42 offset:4480
    ds_read_u16_d16_hi v102, v42 offset:4480
    ds_read_u16_d16_hi v103, v42 offset:4480
    ds_read_u16_d16_hi v104, v42 offset:4544
    ds_read_u16_d16_hi v105, v42 offset:4544
    ds_read_u16_d16_hi v106, v42 offset:4544
    ds_read_u16_d16_hi v107, v42 offset:4544
    s_cmp_eq_u32 s91, 1
    s_cselect_b32 s97, 4, 0
    ds_read_u16 v2, v12 offset:46626
    ds_read_u16 v4, v12 offset:46630
    ds_read_u16 v6, v12 offset:46634
    ds_read_u16 v8, v12 offset:46638
    v_add_u32 v12, 48, v12
    v_add_u32 v13, 48, v13
    s_cmp_lg_u32 s80, 0
    s_cbranch_scc1 K2_ACCLD
    v_mov_b64 v[14:15], s[100:101]
    v_mov_b64 v[16:17], s[100:101]
    v_mov_b64 v[18:19], 0
    v_mov_b64 v[20:21], 0
K2_ACCD:
    s_waitcnt lgkmcnt(4)
    v_mfma_f32_16x16x16_bf16 v[76:79], v[36:37], v[108:109], v[92:95]
    v_mfma_f32_16x16x16_bf16 v[80:83], v[36:37], v[110:111], v[96:99]
    v_mfma_f32_16x16x16_bf16 v[84:87], v[36:37], v[112:113], v[100:103]
    v_mfma_f32_16x16x16_bf16 v[88:91], v[36:37], v[114:115], v[104:107]
    v_lshl_add_u32 v43, v10, 5, v11
    ds_read_b64 v[36:37], v43
    ds_read_u16 v10, v13 offset:46576
K2_ENT:
    s_nop 1
    s_cmp_le_u32 s96, 1
    s_cbranch_scc1 K2_LA
    s_cmp_eq_u32 s96, 2
    s_cbranch_scc1 K2_PA
    .p2align 5
K2_NA:
    s_cmp_gt_u32 s96, s97
    s_cbranch_scc1 .L1_9
    s_setprio 2
.L1_9:
    v_exp_f32 v22, v76
    v_exp_f32 v26, v77
    v_exp_f32 v23, v80
    v_exp_f32 v27, v81
    v_exp_f32 v24, v84
    v_exp_f32 v28, v85
    v_exp_f32 v25, v88
    v_exp_f32 v29, v89
    s_waitcnt vmcnt(6)
    v_lshlrev_b64 v[120:121], 16, v[44:45]
    v_lshlrev_b64 v[124:125], 16, v[48:49]
    v_lshlrev_b64 v[122:123], 16, v[46:47]
    v_lshlrev_b64 v[126:127], 16, v[50:51]
    v_pk_fma_f32 v[22:23], v[22:23], v[120:121], v[34:35] op_sel_hi:[1,1,0] clamp
    v_pk_fma_f32 v[26:27], v[26:27], v[124:125], v[34:35] op_sel_hi:[1,1,0] clamp
    v_pk_fma_f32 v[24:25], v[24:25], v[122:123], v[34:35] op_sel_hi:[1,1,0] clamp
    v_pk_fma_f32 v[28:29], v[28:29], v[126:127], v[34:35] op_sel_hi:[1,1,0] clamp
    v_pk_mul_f32 v[30:31], v[22:23], v[26:27]
    v_pk_mul_f32 v[32:33], v[24:25], v[28:29]
    v_pk_mul_f32 v[116:117], v[44:45], v[26:27]
    v_pk_mul_f32 v[118:119], v[46:47], v[28:29]
    v_pk_fma_f32 v[116:117], v[48:49], v[22:23], v[116:117]
    v_pk_fma_f32 v[118:119], v[50:51], v[24:25], v[118:119]
    v_rcp_f32 v30, v30
    v_rcp_f32 v31, v31
    v_rcp_f32 v32, v32
    v_rcp_f32_e64 v33, v33
    s_waitcnt lgkmcnt(0)
    buffer_load_dwordx4 v[44:47], v[2:3], s[44:47], 0 idxen offen
    buffer_load_dwordx4 v[48:51], v[4:5], s[44:47], 0 idxen offen
    ds_read_u16 v2, v12 offset:46594
    ds_read_u16 v4, v12 offset:46598
    v_pk_add_f32 v[22:23], v[22:23], v[26:27]
    v_pk_add_f32 v[24:25], v[24:25], v[28:29]
    v_pk_fma_f32 v[18:19], v[116:117], v[30:31], v[18:19]
    v_pk_fma_f32 v[20:21], v[118:119], v[32:33], v[20:21]
    v_pk_fma_f32 v[14:15], v[22:23], v[30:31], v[14:15]
    v_pk_fma_f32 v[16:17], v[24:25], v[32:33], v[16:17]
    v_exp_f32 v22, v78
    v_exp_f32 v26, v79
    v_exp_f32_e64 v23, v82
    v_mfma_f32_16x16x16_bf16 v[76:79], v[36:37], v[108:109], v[92:95]
    v_exp_f32 v27, v83
    v_exp_f32 v24, v86
    v_mfma_f32_16x16x16_bf16 v[80:83], v[36:37], v[110:111], v[96:99]
    v_exp_f32 v28, v87
    v_exp_f32 v25, v90
    v_mfma_f32_16x16x16_bf16 v[84:87], v[36:37], v[112:113], v[100:103]
    v_exp_f32 v29, v91
    s_waitcnt vmcnt(6)
    v_lshlrev_b64 v[120:121], 16, v[52:53]
    v_lshlrev_b64 v[124:125], 16, v[56:57]
    v_lshlrev_b64 v[122:123], 16, v[54:55]
    v_lshlrev_b64 v[126:127], 16, v[58:59]
    v_pk_fma_f32 v[22:23], v[22:23], v[120:121], v[34:35] op_sel_hi:[1,1,0] clamp
    v_pk_fma_f32 v[26:27], v[26:27], v[124:125], v[34:35] op_sel_hi:[1,1,0] clamp
    v_pk_fma_f32 v[24:25], v[24:25], v[122:123], v[34:35] op_sel_hi:[1,1,0] clamp
    v_pk_fma_f32 v[28:29], v[28:29], v[126:127], v[34:35] op_sel_hi:[1,1,0] clamp
    v_pk_mul_f32 v[30:31], v[22:23], v[26:27]
    v_pk_mul_f32 v[32:33], v[24:25], v[28:29]
    v_pk_mul_f32 v[116:117], v[52:53], v[26:27]
    v_pk_mul_f32 v[118:119], v[54:55], v[28:29]
    v_pk_fma_f32 v[116:117], v[56:57], v[22:23], v[116:117]
    v_pk_fma_f32 v[118:119], v[58:59], v[24:25], v[118:119]
    v_mfma_f32_16x16x16_bf16 v[88:91], v[36:37], v[114:115], v[104:107]
    v_rcp_f32 v30, v30
    v_rcp_f32 v31, v31
    v_rcp_f32 v32, v32
    v_rcp_f32 v33, v33
    buffer_load_dwordx4 v[52:55], v[6:7], s[44:47], 0 idxen offen
    buffer_load_dwordx4 v[56:59], v[8:9], s[44:47], 0 idxen offen
    ds_read_u16 v6, v12 offset:46602
    ds_read_u16 v8, v12 offset:46606
    v_lshl_add_u32 v43, v10, 5, v11
    ds_read_b64 v[36:37], v43
    ds_read_u16 v10, v13 offset:46592
    v_pk_add_f32 v[22:23], v[22:23], v[26:27]
    v_pk_add_f32 v[24:25], v[24:25], v[28:29]
    v_pk_fma_f32 v[18:19], v[116:117], v[30:31], v[18:19]
    v_pk_fma_f32 v[20:21], v[118:119], v[32:33], v[20:21]
    v_pk_fma_f32 v[14:15], v[22:23], v[30:31], v[14:15]
    v_pk_fma_f32 v[16:17], v[24:25], v[32:33], v[16:17]
    s_sub_u32 s96, s96, 1
    s_cmp_eq_u32 s96, 2
    s_cbranch_scc1 K2_PB
K2_NB:
    s_cmp_gt_u32 s96, s97
    s_cbranch_scc1 .L1_10
    s_setprio 2
.L1_10:
    v_exp_f32 v22, v76
    v_exp_f32 v26, v77
    v_exp_f32 v23, v80
    v_exp_f32 v27, v81
    v_exp_f32 v24, v84
    v_exp_f32 v28, v85
    v_exp_f32 v25, v88
    v_exp_f32_e64 v29, v89
    s_waitcnt vmcnt(6)
    v_lshlrev_b64 v[120:121], 16, v[60:61]
    v_lshlrev_b64 v[124:125], 16, v[64:65]
    v_lshlrev_b64 v[122:123], 16, v[62:63]
    v_lshlrev_b64 v[126:127], 16, v[66:67]
    v_pk_fma_f32 v[22:23], v[22:23], v[120:121], v[34:35] op_sel_hi:[1,1,0] clamp
    v_pk_fma_f32 v[26:27], v[26:27], v[124:125], v[34:35] op_sel_hi:[1,1,0] clamp
    v_pk_fma_f32 v[24:25], v[24:25], v[122:123], v[34:35] op_sel_hi:[1,1,0] clamp
    v_pk_fma_f32 v[28:29], v[28:29], v[126:127], v[34:35] op_sel_hi:[1,1,0] clamp
    v_pk_mul_f32 v[30:31], v[22:23], v[26:27]
    v_pk_mul_f32 v[32:33], v[24:25], v[28:29]
    v_pk_mul_f32 v[116:117], v[60:61], v[26:27]
    v_pk_mul_f32 v[118:119], v[62:63], v[28:29]
    v_pk_fma_f32 v[116:117], v[64:65], v[22:23], v[116:117]
    v_pk_fma_f32 v[118:119], v[66:67], v[24:25], v[118:119]
    v_rcp_f32 v30, v30
    v_rcp_f32 v31, v31
    v_rcp_f32 v32, v32
    v_rcp_f32_e64 v33, v33
    s_waitcnt lgkmcnt(0)
    buffer_load_dwordx4 v[60:63], v[2:3], s[44:47], 0 idxen offen
    buffer_load_dwordx4 v[64:67], v[4:5], s[44:47], 0 idxen offen
    ds_read_u16 v2, v12 offset:46610
    ds_read_u16 v4, v12 offset:46614
    v_pk_add_f32 v[22:23], v[22:23], v[26:27]
    v_pk_add_f32 v[24:25], v[24:25], v[28:29]
    v_pk_fma_f32 v[18:19], v[116:117], v[30:31], v[18:19]
    v_pk_fma_f32 v[20:21], v[118:119], v[32:33], v[20:21]
    v_pk_fma_f32 v[14:15], v[22:23], v[30:31], v[14:15]
    v_pk_fma_f32 v[16:17], v[24:25], v[32:33], v[16:17]
    v_exp_f32 v22, v78
    v_exp_f32 v26, v79
    v_exp_f32_e64 v23, v82
    v_mfma_f32_16x16x16_bf16 v[76:79], v[36:37], v[108:109], v[92:95]
    v_exp_f32 v27, v83
    v_exp_f32 v24, v86
    v_mfma_f32_16x16x16_bf16 v[80:83], v[36:37], v[110:111], v[96:99]
    v_exp_f32 v28, v87
    v_exp_f32 v25, v90
    v_mfma_f32_16x16x16_bf16 v[84:87], v[36:37], v[112:113], v[100:103]
    v_exp_f32 v29, v91
    s_waitcnt vmcnt(6)
    v_lshlrev_b64 v[120:121], 16, v[68:69]
    v_lshlrev_b64 v[124:125], 16, v[72:73]
    v_lshlrev_b64 v[122:123], 16, v[70:71]
    v_lshlrev_b64 v[126:127], 16, v[74:75]
    v_pk_fma_f32 v[22:23], v[22:23], v[120:121], v[34:35] op_sel_hi:[1,1,0] clamp
    v_pk_fma_f32 v[26:27], v[26:27], v[124:125], v[34:35] op_sel_hi:[1,1,0] clamp
    v_pk_fma_f32 v[24:25], v[24:25], v[122:123], v[34:35] op_sel_hi:[1,1,0] clamp
    v_pk_fma_f32 v[28:29], v[28:29], v[126:127], v[34:35] op_sel_hi:[1,1,0] clamp
    v_pk_mul_f32 v[30:31], v[22:23], v[26:27]
    v_pk_mul_f32 v[32:33], v[24:25], v[28:29]
    v_pk_mul_f32 v[116:117], v[68:69], v[26:27]
    v_pk_mul_f32 v[118:119], v[70:71], v[28:29]
    v_pk_fma_f32 v[116:117], v[72:73], v[22:23], v[116:117]
    v_pk_fma_f32 v[118:119], v[74:75], v[24:25], v[118:119]
    v_mfma_f32_16x16x16_bf16 v[88:91], v[36:37], v[114:115], v[104:107]
    v_rcp_f32 v30, v30
    v_rcp_f32 v31, v31
    v_rcp_f32 v32, v32
    v_rcp_f32 v33, v33
    buffer_load_dwordx4 v[68:71], v[6:7], s[44:47], 0 idxen offen
    buffer_load_dwordx4 v[72:75], v[8:9], s[44:47], 0 idxen offen
    ds_read_u16 v6, v12 offset:46618
    ds_read_u16 v8, v12 offset:46622
    v_lshl_add_u32 v43, v10, 5, v11
    ds_read_b64 v[36:37], v43
    ds_read_u16 v10, v13 offset:46608
    v_add_u32 v12, 32, v12
    v_add_u32 v13, 32, v13
    v_pk_add_f32 v[22:23], v[22:23], v[26:27]
    v_pk_add_f32 v[24:25], v[24:25], v[28:29]
    v_pk_fma_f32 v[18:19], v[116:117], v[30:31], v[18:19]
    v_pk_fma_f32 v[20:21], v[118:119], v[32:33], v[20:21]
    v_pk_fma_f32 v[14:15], v[22:23], v[30:31], v[14:15]
    v_pk_fma_f32 v[16:17], v[24:25], v[32:33], v[16:17]
    s_sub_u32 s96, s96, 1
    s_cmp_eq_u32 s96, 2
    s_cbranch_scc0 K2_NA
K2_PA:
    s_cmp_eq_u32 s97, 0
    s_cbranch_scc1 .L1_11
    s_setprio 1
.L1_11:
    v_exp_f32 v22, v76
    v_exp_f32 v26, v77
    v_exp_f32 v23, v80
    v_exp_f32 v27, v81
    v_exp_f32 v24, v84
    v_exp_f32 v28, v85
    v_exp_f32 v25, v88
    v_exp_f32_e64 v29, v89
    s_waitcnt vmcnt(6)
    v_lshlrev_b64 v[120:121], 16, v[44:45]
    v_lshlrev_b64 v[124:125], 16, v[48:49]
    v_lshlrev_b64 v[122:123], 16, v[46:47]
    v_lshlrev_b64 v[126:127], 16, v[50:51]
    v_pk_fma_f32 v[22:23], v[22:23], v[120:121], v[34:35] op_sel_hi:[1,1,0] clamp
    v_pk_fma_f32 v[26:27], v[26:27], v[124:125], v[34:35] op_sel_hi:[1,1,0] clamp
    v_pk_fma_f32 v[24:25], v[24:25], v[122:123], v[34:35] op_sel_hi:[1,1,0] clamp
    v_pk_fma_f32 v[28:29], v[28:29], v[126:127], v[34:35] op_sel_hi:[1,1,0] clamp
    v_pk_mul_f32 v[30:31], v[22:23], v[26:27]
    v_pk_mul_f32 v[32:33], v[24:25], v[28:29]
    v_pk_mul_f32 v[116:117], v[44:45], v[26:27]
    v_pk_mul_f32 v[118:119], v[46:47], v[28:29]
    v_pk_fma_f32 v[116:117], v[48:49], v[22:23], v[116:117]
    v_pk_fma_f32 v[118:119], v[50:51], v[24:25], v[118:119]
    v_rcp_f32 v30, v30
    v_rcp_f32 v31, v31
    v_rcp_f32 v32, v32
    v_rcp_f32_e64 v33, v33
    s_waitcnt lgkmcnt(0)
    v_pk_add_f32 v[22:23], v[22:23], v[26:27]
    v_pk_add_f32 v[24:25], v[24:25], v[28:29]
    v_pk_fma_f32 v[18:19], v[116:117], v[30:31], v[18:19]
    v_pk_fma_f32 v[20:21], v[118:119], v[32:33], v[20:21]
    v_pk_fma_f32 v[14:15], v[22:23], v[30:31], v[14:15]
    v_pk_fma_f32 v[16:17], v[24:25], v[32:33], v[16:17]
    v_exp_f32 v22, v78
    v_exp_f32 v26, v79
    v_exp_f32_e64 v23, v82
    v_mfma_f32_16x16x16_bf16 v[76:79], v[36:37], v[108:109], v[92:95]
    v_exp_f32 v27, v83
    v_exp_f32 v24, v86
    v_mfma_f32_16x16x16_bf16 v[80:83], v[36:37], v[110:111], v[96:99]
    v_exp_f32 v28, v87
    v_exp_f32 v25, v90
    v_mfma_f32_16x16x16_bf16 v[84:87], v[36:37], v[112:113], v[100:103]
    v_exp_f32 v29, v91
    s_waitcnt vmcnt(4)
    v_lshlrev_b64 v[120:121], 16, v[52:53]
    v_lshlrev_b64 v[124:125], 16, v[56:57]
    v_lshlrev_b64 v[122:123], 16, v[54:55]
    v_lshlrev_b64 v[126:127], 16, v[58:59]
    v_pk_fma_f32 v[22:23], v[22:23], v[120:121], v[34:35] op_sel_hi:[1,1,0] clamp
    v_pk_fma_f32 v[26:27], v[26:27], v[124:125], v[34:35] op_sel_hi:[1,1,0] clamp
    v_pk_fma_f32 v[24:25], v[24:25], v[122:123], v[34:35] op_sel_hi:[1,1,0] clamp
    v_pk_fma_f32 v[28:29], v[28:29], v[126:127], v[34:35] op_sel_hi:[1,1,0] clamp
    v_pk_mul_f32 v[30:31], v[22:23], v[26:27]
    v_pk_mul_f32 v[32:33], v[24:25], v[28:29]
    v_pk_mul_f32 v[116:117], v[52:53], v[26:27]
    v_pk_mul_f32 v[118:119], v[54:55], v[28:29]
    v_pk_fma_f32 v[116:117], v[56:57], v[22:23], v[116:117]
    v_pk_fma_f32 v[118:119], v[58:59], v[24:25], v[118:119]
    v_mfma_f32_16x16x16_bf16 v[88:91], v[36:37], v[114:115], v[104:107]
    v_rcp_f32 v30, v30
    v_rcp_f32 v31, v31
    v_rcp_f32 v32, v32
    v_rcp_f32 v33, v33
    v_pk_add_f32 v[22:23], v[22:23], v[26:27]
    v_pk_add_f32 v[24:25], v[24:25], v[28:29]
    v_pk_fma_f32 v[18:19], v[116:117], v[30:31], v[18:19]
    v_pk_fma_f32 v[20:21], v[118:119], v[32:33], v[20:21]
    v_pk_fma_f32 v[14:15], v[22:23], v[30:31], v[14:15]
    v_pk_fma_f32 v[16:17], v[24:25], v[32:33], v[16:17]
K2_LB:
    s_cmp_eq_u32 s97, 0
    s_cbranch_scc1 .L1_12
    s_setprio 0
.L1_12:
    v_exp_f32 v22, v76
    v_exp_f32 v26, v77
    v_exp_f32 v23, v80
    v_exp_f32 v27, v81
    v_exp_f32 v24, v84
    v_exp_f32 v28, v85
    v_exp_f32 v25, v88
    v_exp_f32 v29, v89
    s_waitcnt vmcnt(2)
    v_lshlrev_b64 v[120:121], 16, v[60:61]
    v_lshlrev_b64 v[124:125], 16, v[64:65]
    v_lshlrev_b64 v[122:123], 16, v[62:63]
    v_lshlrev_b64 v[126:127], 16, v[66:67]
    v_pk_fma_f32 v[22:23], v[22:23], v[120:121], v[34:35] op_sel_hi:[1,1,0] clamp
    v_pk_fma_f32 v[26:27], v[26:27], v[124:125], v[34:35] op_sel_hi:[1,1,0] clamp
    v_pk_fma_f32 v[24:25], v[24:25], v[122:123], v[34:35] op_sel_hi:[1,1,0] clamp
    v_pk_fma_f32 v[28:29], v[28:29], v[126:127], v[34:35] op_sel_hi:[1,1,0] clamp
    v_pk_mul_f32 v[30:31], v[22:23], v[26:27]
    v_pk_mul_f32 v[32:33], v[24:25], v[28:29]
    v_pk_mul_f32 v[116:117], v[60:61], v[26:27]
    v_pk_mul_f32 v[118:119], v[62:63], v[28:29]
    v_pk_fma_f32 v[116:117], v[64:65], v[22:23], v[116:117]
    v_pk_fma_f32 v[118:119], v[66:67], v[24:25], v[118:119]
    v_rcp_f32 v30, v30
    v_rcp_f32 v31, v31
    v_rcp_f32 v32, v32
    v_rcp_f32 v33, v33
    v_pk_add_f32 v[22:23], v[22:23], v[26:27]
    v_pk_add_f32 v[24:25], v[24:25], v[28:29]
    v_pk_fma_f32 v[18:19], v[116:117], v[30:31], v[18:19]
    v_pk_fma_f32 v[20:21], v[118:119], v[32:33], v[20:21]
    v_pk_fma_f32 v[14:15], v[22:23], v[30:31], v[14:15]
    v_pk_fma_f32 v[16:17], v[24:25], v[32:33], v[16:17]
    s_bitcmp1_b32 s93, 0
    s_cbranch_scc1 K2_FIN
    v_exp_f32 v22, v78
    v_exp_f32 v26, v79
    v_exp_f32 v23, v82
    v_exp_f32 v27, v83
    v_exp_f32 v24, v86
    v_exp_f32 v28, v87
    v_exp_f32 v25, v90
    v_exp_f32_e64 v29, v91
    s_waitcnt vmcnt(0)
    v_lshlrev_b64 v[120:121], 16, v[68:69]
    v_lshlrev_b64 v[124:125], 16, v[72:73]
    v_lshlrev_b64 v[122:123], 16, v[70:71]
    v_lshlrev_b64 v[126:127], 16, v[74:75]
    v_pk_fma_f32 v[22:23], v[22:23], v[120:121], v[34:35] op_sel_hi:[1,1,0] clamp
    v_pk_fma_f32 v[26:27], v[26:27], v[124:125], v[34:35] op_sel_hi:[1,1,0] clamp
    v_pk_fma_f32 v[24:25], v[24:25], v[122:123], v[34:35] op_sel_hi:[1,1,0] clamp
    v_pk_fma_f32 v[28:29], v[28:29], v[126:127], v[34:35] op_sel_hi:[1,1,0] clamp
    v_pk_mul_f32 v[30:31], v[22:23], v[26:27]
    v_pk_mul_f32 v[32:33], v[24:25], v[28:29]
    v_pk_mul_f32 v[116:117], v[68:69], v[26:27]
    v_pk_mul_f32 v[118:119], v[70:71], v[28:29]
    v_pk_fma_f32 v[116:117], v[72:73], v[22:23], v[116:117]
    v_pk_fma_f32 v[118:119], v[74:75], v[24:25], v[118:119]
    v_rcp_f32 v30, v30
    v_rcp_f32 v31, v31
    v_rcp_f32 v32, v32
    v_rcp_f32 v33, v33
    v_pk_add_f32 v[22:23], v[22:23], v[26:27]
    v_pk_add_f32 v[24:25], v[24:25], v[28:29]
    v_pk_fma_f32 v[18:19], v[116:117], v[30:31], v[18:19]
    v_pk_fma_f32 v[20:21], v[118:119], v[32:33], v[20:21]
    v_pk_fma_f32 v[14:15], v[22:23], v[30:31], v[14:15]
    v_pk_fma_f32 v[16:17], v[24:25], v[32:33], v[16:17]
    s_branch K2_FIN
K2_PB:
    s_cmp_eq_u32 s97, 0
    s_cbranch_scc1 .L1_13
    s_setprio 1
.L1_13:
    v_exp_f32 v22, v76
    v_exp_f32 v26, v77
    v_exp_f32 v23, v80
    v_exp_f32 v27, v81
    v_exp_f32 v24, v84
    v_exp_f32 v28, v85
    v_exp_f32 v25, v88
    v_exp_f32_e64 v29, v89
    s_waitcnt vmcnt(6)
    v_lshlrev_b64 v[120:121], 16, v[60:61]
    v_lshlrev_b64 v[124:125], 16, v[64:65]
    v_lshlrev_b64 v[122:123], 16, v[62:63]
    v_lshlrev_b64 v[126:127], 16, v[66:67]
    v_pk_fma_f32 v[22:23], v[22:23], v[120:121], v[34:35] op_sel_hi:[1,1,0] clamp
    v_pk_fma_f32 v[26:27], v[26:27], v[124:125], v[34:35] op_sel_hi:[1,1,0] clamp
    v_pk_fma_f32 v[24:25], v[24:25], v[122:123], v[34:35] op_sel_hi:[1,1,0] clamp
    v_pk_fma_f32 v[28:29], v[28:29], v[126:127], v[34:35] op_sel_hi:[1,1,0] clamp
    v_pk_mul_f32 v[30:31], v[22:23], v[26:27]
    v_pk_mul_f32 v[32:33], v[24:25], v[28:29]
    v_pk_mul_f32 v[116:117], v[60:61], v[26:27]
    v_pk_mul_f32 v[118:119], v[62:63], v[28:29]
    v_pk_fma_f32 v[116:117], v[64:65], v[22:23], v[116:117]
    v_pk_fma_f32 v[118:119], v[66:67], v[24:25], v[118:119]
    v_rcp_f32 v30, v30
    v_rcp_f32 v31, v31
    v_rcp_f32 v32, v32
    v_rcp_f32_e64 v33, v33
    s_waitcnt lgkmcnt(0)
    v_pk_add_f32 v[22:23], v[22:23], v[26:27]
    v_pk_add_f32 v[24:25], v[24:25], v[28:29]
    v_pk_fma_f32 v[18:19], v[116:117], v[30:31], v[18:19]
    v_pk_fma_f32 v[20:21], v[118:119], v[32:33], v[20:21]
    v_pk_fma_f32 v[14:15], v[22:23], v[30:31], v[14:15]
    v_pk_fma_f32 v[16:17], v[24:25], v[32:33], v[16:17]
    v_exp_f32 v22, v78
    v_exp_f32 v26, v79
    v_exp_f32_e64 v23, v82
    v_mfma_f32_16x16x16_bf16 v[76:79], v[36:37], v[108:109], v[92:95]
    v_exp_f32 v27, v83
    v_exp_f32 v24, v86
    v_mfma_f32_16x16x16_bf16 v[80:83], v[36:37], v[110:111], v[96:99]
    v_exp_f32 v28, v87
    v_exp_f32 v25, v90
    v_mfma_f32_16x16x16_bf16 v[84:87], v[36:37], v[112:113], v[100:103]
    v_exp_f32 v29, v91
    s_waitcnt vmcnt(4)
    v_lshlrev_b64 v[120:121], 16, v[68:69]
    v_lshlrev_b64 v[124:125], 16, v[72:73]
    v_lshlrev_b64 v[122:123], 16, v[70:71]
    v_lshlrev_b64 v[126:127], 16, v[74:75]
    v_pk_fma_f32 v[22:23], v[22:23], v[120:121], v[34:35] op_sel_hi:[1,1,0] clamp
    v_pk_fma_f32 v[26:27], v[26:27], v[124:125], v[34:35] op_sel_hi:[1,1,0] clamp
    v_pk_fma_f32 v[24:25], v[24:25], v[122:123], v[34:35] op_sel_hi:[1,1,0] clamp
    v_pk_fma_f32 v[28:29], v[28:29], v[126:127], v[34:35] op_sel_hi:[1,1,0] clamp
    v_pk_mul_f32 v[30:31], v[22:23], v[26:27]
    v_pk_mul_f32 v[32:33], v[24:25], v[28:29]
    v_pk_mul_f32 v[116:117], v[68:69], v[26:27]
    v_pk_mul_f32 v[118:119], v[70:71], v[28:29]
    v_pk_fma_f32 v[116:117], v[72:73], v[22:23], v[116:117]
    v_pk_fma_f32 v[118:119], v[74:75], v[24:25], v[118:119]
    v_mfma_f32_16x16x16_bf16 v[88:91], v[36:37], v[114:115], v[104:107]
    v_rcp_f32 v30, v30
    v_rcp_f32 v31, v31
    v_rcp_f32 v32, v32
    v_rcp_f32 v33, v33
    v_pk_add_f32 v[22:23], v[22:23], v[26:27]
    v_pk_add_f32 v[24:25], v[24:25], v[28:29]
    v_pk_fma_f32 v[18:19], v[116:117], v[30:31], v[18:19]
    v_pk_fma_f32 v[20:21], v[118:119], v[32:33], v[20:21]
    v_pk_fma_f32 v[14:15], v[22:23], v[30:31], v[14:15]
    v_pk_fma_f32 v[16:17], v[24:25], v[32:33], v[16:17]
K2_LA:
    s_cmp_eq_u32 s97, 0
    s_cbranch_scc1 .L1_14
    s_setprio 0
.L1_14:
    v_exp_f32 v22, v76
    v_exp_f32 v26, v77
    v_exp_f32 v23, v80
    v_exp_f32 v27, v81
    v_exp_f32 v24, v84
    v_exp_f32 v28, v85
    v_exp_f32 v25, v88
    v_exp_f32 v29, v89
    s_waitcnt vmcnt(2)
    v_lshlrev_b64 v[120:121], 16, v[44:45]
    v_lshlrev_b64 v[124:125], 16, v[48:49]
    v_lshlrev_b64 v[122:123], 16, v[46:47]
    v_lshlrev_b64 v[126:127], 16, v[50:51]
    v_pk_fma_f32 v[22:23], v[22:23], v[120:121], v[34:35] op_sel_hi:[1,1,0] clamp
    v_pk_fma_f32 v[26:27], v[26:27], v[124:125], v[34:35] op_sel_hi:[1,1,0] clamp
    v_pk_fma_f32 v[24:25], v[24:25], v[122:123], v[34:35] op_sel_hi:[1,1,0] clamp
    v_pk_fma_f32 v[28:29], v[28:29], v[126:127], v[34:35] op_sel_hi:[1,1,0] clamp
    v_pk_mul_f32 v[30:31], v[22:23], v[26:27]
    v_pk_mul_f32 v[32:33], v[24:25], v[28:29]
    v_pk_mul_f32 v[116:117], v[44:45], v[26:27]
    v_pk_mul_f32 v[118:119], v[46:47], v[28:29]
    v_pk_fma_f32 v[116:117], v[48:49], v[22:23], v[116:117]
    v_pk_fma_f32 v[118:119], v[50:51], v[24:25], v[118:119]
    v_rcp_f32 v30, v30
    v_rcp_f32 v31, v31
    v_rcp_f32 v32, v32
    v_rcp_f32 v33, v33
    v_pk_add_f32 v[22:23], v[22:23], v[26:27]
    v_pk_add_f32 v[24:25], v[24:25], v[28:29]
    v_pk_fma_f32 v[18:19], v[116:117], v[30:31], v[18:19]
    v_pk_fma_f32 v[20:21], v[118:119], v[32:33], v[20:21]
    v_pk_fma_f32 v[14:15], v[22:23], v[30:31], v[14:15]
    v_pk_fma_f32 v[16:17], v[24:25], v[32:33], v[16:17]
    s_bitcmp1_b32 s93, 0
    s_cbranch_scc1 K2_FIN
    v_exp_f32 v22, v78
    v_exp_f32 v26, v79
    v_exp_f32 v23, v82
    v_exp_f32 v27, v83
    v_exp_f32 v24, v86
    v_exp_f32 v28, v87
    v_exp_f32 v25, v90
    v_exp_f32_e64 v29, v91
    s_waitcnt vmcnt(0)
    v_lshlrev_b64 v[120:121], 16, v[52:53]
    v_lshlrev_b64 v[124:125], 16, v[56:57]
    v_lshlrev_b64 v[122:123], 16, v[54:55]
    v_lshlrev_b64 v[126:127], 16, v[58:59]
    v_pk_fma_f32 v[22:23], v[22:23], v[120:121], v[34:35] op_sel_hi:[1,1,0] clamp
    v_pk_fma_f32 v[26:27], v[26:27], v[124:125], v[34:35] op_sel_hi:[1,1,0] clamp
    v_pk_fma_f32 v[24:25], v[24:25], v[122:123], v[34:35] op_sel_hi:[1,1,0] clamp
    v_pk_fma_f32 v[28:29], v[28:29], v[126:127], v[34:35] op_sel_hi:[1,1,0] clamp
    v_pk_mul_f32 v[30:31], v[22:23], v[26:27]
    v_pk_mul_f32 v[32:33], v[24:25], v[28:29]
    v_pk_mul_f32 v[116:117], v[52:53], v[26:27]
    v_pk_mul_f32 v[118:119], v[54:55], v[28:29]
    v_pk_fma_f32 v[116:117], v[56:57], v[22:23], v[116:117]
    v_pk_fma_f32 v[118:119], v[58:59], v[24:25], v[118:119]
    v_rcp_f32 v30, v30
    v_rcp_f32 v31, v31
    v_rcp_f32 v32, v32
    v_rcp_f32 v33, v33
    v_pk_add_f32 v[22:23], v[22:23], v[26:27]
    v_pk_add_f32 v[24:25], v[24:25], v[28:29]
    v_pk_fma_f32 v[18:19], v[116:117], v[30:31], v[18:19]
    v_pk_fma_f32 v[20:21], v[118:119], v[32:33], v[20:21]
    v_pk_fma_f32 v[14:15], v[22:23], v[30:31], v[14:15]
    v_pk_fma_f32 v[16:17], v[24:25], v[32:33], v[16:17]
K2_FIN:
    s_cmp_eq_u32 s81, 0
    s_cbranch_scc1 K2_SAVE
    ds_read_u16_d16_hi v22, v42 offset:4354
    ds_read_u16_d16_hi v23, v42 offset:4418
    ds_read_u16_d16_hi v24, v42 offset:4482
    ds_read_u16_d16_hi v25, v42 offset:4546
    v_rcp_f32 v14, v14
    v_rcp_f32 v15, v15
    v_rcp_f32 v16, v16
    v_rcp_f32 v17, v17
    s_waitcnt vmcnt(0) lgkmcnt(0)
    v_pk_fma_f32 v[22:23], v[18:19], v[14:15], v[22:23]
    v_pk_fma_f32 v[24:25], v[20:21], v[16:17], v[24:25]
    v_max_f32 v22, 0, v22
    v_max_f32 v23, 0, v23
    v_max_f32 v24, 0, v24
    v_max_f32 v25, 0, v25
    v_dot2c_f32_bf16 v22, s95, v38
    v_dot2c_f32_bf16 v23, s92, v38
    v_dot2c_f32_bf16 v24, s95, v39
    v_dot2c_f32_bf16 v25, s92, v39
    s_sub_u32 s91, s91, 1
    s_mov_b32 s90, s94
    v_cvt_pk_bf16_f32 v116, v22, v23
    v_cvt_pk_bf16_f32 v117, v24, v25
    buffer_store_dwordx2 v[116:117], v41, s[52:55], 0 offen sc1
K2_NEXT:
    s_cmp_lg_u32 s91, 0
    s_cbranch_scc1 K2_GROUP
    s_cmp_lg_u32 s81, 0
    s_cbranch_scc1 K2_END
    s_mov_b32 s80, 1
    s_branch K2_SLOWROUND
K2_OV:
    s_mov_b32 s88, 1
    s_mov_b32 s36, 0
    v_mov_b64 v[72:73], 0
    v_readlane_b32 s35, v65, 0
    v_readlane_b32 s34, v64, 0
    s_cmp_le_u32 s35, 32
    s_cbranch_scc1 .L1_1
    s_cmp_gt_u32 s35, 64
    s_cselect_b32 s36, 2, s36
    s_cmp_eq_u32 s36, 0
    s_cselect_b32 exec_lo, -1, 0
    s_cselect_b32 exec_hi, 0, -1
    s_add_u32 s36, s36, 1
    s_add_u32 s34, s34, 128
    s_sub_u32 s35, s35, 32
    v_mov_b32 v72, s34
    v_mov_b32 v73, s35
    s_mov_b64 exec, -1
.L1_1:
    v_readlane_b32 s35, v65, 32
    v_readlane_b32 s34, v64, 32
    s_cmp_le_u32 s35, 32
    s_cbranch_scc1 .L1_2
    s_cmp_gt_u32 s35, 64
    s_cselect_b32 s36, 2, s36
    s_cmp_eq_u32 s36, 0
    s_cselect_b32 exec_lo, -1, 0
    s_cselect_b32 exec_hi, 0, -1
    s_add_u32 s36, s36, 1
    s_add_u32 s34, s34, 128
    s_sub_u32 s35, s35, 32
    v_mov_b32 v72, s34
    v_mov_b32 v73, s35
    s_mov_b64 exec, -1
.L1_2:
    v_readlane_b32 s35, v67, 0
    v_readlane_b32 s34, v66, 0
    s_cmp_le_u32 s35, 32
    s_cbranch_scc1 .L1_3
    s_cmp_gt_u32 s35, 64
    s_cselect_b32 s36, 2, s36
    s_cmp_eq_u32 s36, 0
    s_cselect_b32 exec_lo, -1, 0
    s_cselect_b32 exec_hi, 0, -1
    s_add_u32 s36, s36, 1
    s_add_u32 s34, s34, 128
    s_sub_u32 s35, s35, 32
    v_mov_b32 v72, s34
    v_mov_b32 v73, s35
    s_mov_b64 exec, -1
.L1_3:
    v_readlane_b32 s35, v67, 32
    v_readlane_b32 s34, v66, 32
    s_cmp_le_u32 s35, 32
    s_cbranch_scc1 .L1_4
    s_cmp_gt_u32 s35, 64
    s_cselect_b32 s36, 2, s36
    s_cmp_eq_u32 s36, 0
    s_cselect_b32 exec_lo, -1, 0
    s_cselect_b32 exec_hi, 0, -1
    s_add_u32 s36, s36, 1
    s_add_u32 s34, s34, 128
    s_sub_u32 s35, s35, 32
    v_mov_b32 v72, s34
    v_mov_b32 v73, s35
    s_mov_b64 exec, -1
.L1_4:
    v_readlane_b32 s35, v69, 0
    v_readlane_b32 s34, v68, 0
    s_cmp_le_u32 s35, 32
    s_cbranch_scc1 .L1_5
    s_cmp_gt_u32 s35, 64
    s_cselect_b32 s36, 2, s36
    s_cmp_eq_u32 s36, 0
    s_cselect_b32 exec_lo, -1, 0
    s_cselect_b32 exec_hi, 0, -1
    s_add_u32 s36, s36, 1
    s_add_u32 s34, s34, 128
    s_sub_u32 s35, s35, 32
    v_mov_b32 v72, s34
    v_mov_b32 v73, s35
    s_mov_b64 exec, -1
.L1_5:
    v_readlane_b32 s35, v69, 32
    v_readlane_b32 s34, v68, 32
    s_cmp_le_u32 s35, 32
    s_cbranch_scc1 .L1_6
    s_cmp_gt_u32 s35, 64
    s_cselect_b32 s36, 2, s36
    s_cmp_eq_u32 s36, 0
    s_cselect_b32 exec_lo, -1, 0
    s_cselect_b32 exec_hi, 0, -1
    s_add_u32 s36, s36, 1
    s_add_u32 s34, s34, 128
    s_sub_u32 s35, s35, 32
    v_mov_b32 v72, s34
    v_mov_b32 v73, s35
    s_mov_b64 exec, -1
.L1_6:
    v_readlane_b32 s35, v71, 0
    v_readlane_b32 s34, v70, 0
    s_cmp_le_u32 s35, 32
    s_cbranch_scc1 .L1_7
    s_cmp_gt_u32 s35, 64
    s_cselect_b32 s36, 2, s36
    s_cmp_eq_u32 s36, 0
    s_cselect_b32 exec_lo, -1, 0
    s_cselect_b32 exec_hi, 0, -1
    s_add_u32 s36, s36, 1
    s_add_u32 s34, s34, 128
    s_sub_u32 s35, s35, 32
    v_mov_b32 v72, s34
    v_mov_b32 v73, s35
    s_mov_b64 exec, -1
.L1_7:
    v_readlane_b32 s35, v71, 32
    v_readlane_b32 s34, v70, 32
    s_cmp_le_u32 s35, 32
    s_cbranch_scc1 .L1_8
    s_cmp_gt_u32 s35, 64
    s_cselect_b32 s36, 2, s36
    s_cmp_eq_u32 s36, 0
    s_cselect_b32 exec_lo, -1, 0
    s_cselect_b32 exec_hi, 0, -1
    s_add_u32 s36, s36, 1
    s_add_u32 s34, s34, 128
    s_sub_u32 s35, s35, 32
    v_mov_b32 v72, s34
    v_mov_b32 v73, s35
    s_mov_b64 exec, -1
.L1_8:
    s_cmp_le_u32 s36, 2
    s_cbranch_scc1 K2_NOV
    v_mov_b32 v124, 0
    ds_max_u32 v124, v125 offset:2180
K2_NOV:
    v_cmp_lt_u32 s[72:73], v57, v73
    v_lshl_add_u32 v22, v57, 2, v72
    s_nop 0
    s_mov_b64 exec, s[72:73]
    global_load_dword v30, v22, s[60:61]
    s_mov_b64 exec, -1
    s_bcnt1_i32_b64 s33, s[72:73]
    s_add_u32 s63, s56, s33
    s_branch K2_NOU1
K2_R0:
    s_cmp_ge_u32 s28, 12
    s_cbranch_scc1 K2_R2
    s_cmp_ge_u32 s28, 4
    s_cbranch_scc1 K2_R1
    v_lshrrev_b32 v45, 4, v0
    v_lshl_add_u32 v45, s34, 2, v45
    v_xor_b32 v44, v45, v0
    v_and_b32 v44, 15, v44
    v_lshlrev_b32 v44, 4, v44
    v_add_u32 v45, s31, v45
    v_lshl_add_u32 v44, v45, 8, v44
    s_lshl_b32 s35, s34, 10
    s_add_u32 s35, s35, 26112
    s_mov_b32 s33, 0
    s_mov_b32 m0, s35
    s_add_u32 s35, s35, 4096
    buffer_load_dwordx4 v44, s[40:43], s33 offen lds
    s_add_u32 s33, s33, 4096
    s_mov_b32 m0, s35
    s_add_u32 s35, s35, 4096
    buffer_load_dwordx4 v44, s[40:43], s33 offen lds
    s_add_u32 s33, s33, 4096
    s_mov_b32 m0, s35
    s_add_u32 s35, s35, 4096
    buffer_load_dwordx4 v44, s[40:43], s33 offen lds
    s_add_u32 s33, s33, 4096
    s_mov_b32 m0, s35
    s_add_u32 s35, s35, 4096
    buffer_load_dwordx4 v44, s[40:43], s33 offen lds
    s_add_u32 s33, s33, 4096
    s_mov_b32 m0, s35
    s_add_u32 s35, s35, 4096
    buffer_load_dwordx4 v44, s[40:43], s33 offen lds
    s_lshl_b32 s33, s34, 9
    s_add_u32 m0, s33, 2304
    s_lshl_b32 s35, s29, 11
    s_add_u32 s33, s33, s35
    s_add_u32 s33, s33, 18087936
    v_lshl_add_u32 v45, v0, 4, s33
    s_mov_b32 exec_hi, 0
    global_load_lds_dwordx4 v45, s[26:27]
    s_mov_b32 exec_hi, -1
    s_branch K2_RD
K2_R2:
    s_lshl3_add_u32 s33, s29, s34
    s_lshl_b32 s33, s33, 12
    s_add_u32 s33, s33, 18120704
    v_lshl_add_u32 v44, v0, 4, s33
    v_add_u32 v45, 0x4000, v44
    global_load_dwordx4 v[76:79], v44, s[26:27] offset:0
    global_load_dwordx4 v[80:83], v44, s[26:27] offset:1024
    global_load_dwordx4 v[84:87], v44, s[26:27] offset:2048
    global_load_dwordx4 v[88:91], v44, s[26:27] offset:3072
    global_load_dwordx4 v[92:95], v45, s[26:27] offset:0
    global_load_dwordx4 v[96:99], v45, s[26:27] offset:1024
    global_load_dwordx4 v[100:103], v45, s[26:27] offset:2048
    global_load_dwordx4 v[104:107], v45, s[26:27] offset:3072
    s_branch K2_RD
K2_R1:
    s_lshl_b32 s33, s29, 12
    s_add_u32 s33, s33, 18096128
    v_lshl_add_u32 v44, v0, 6, s33
    global_load_dword v58, v44, s[26:27]
    s_branch K2_RD
K2_PW:
    s_cmp_eq_u32 s28, 11
    s_cbranch_scc1 K2_PX
    s_cmp_lg_u32 s82, 0
    s_cbranch_scc1 K2_B15
    s_setprio 3
    s_branch K2_B15
K2_PX:
    s_setprio 3
    v_lshlrev_b32 v14, 4, v0
    v_mov_b64 v[22:23], 0
    v_mov_b64 v[24:25], 0
    ds_read_b128 v[18:21], v14 offset:0
    s_mov_b64 exec, 0xffff
    ds_read_b128 v[22:25], v14 offset:1024
    s_mov_b64 exec, -1
    s_waitcnt lgkmcnt(0)
    v_add3_u32 v16, v18, v19, v20
    v_add3_u32 v17, v22, v23, v24
    v_add_u32 v20, v18, v19
    v_add_u32 v24, v22, v23
    v_mov_b32 v19, v18
    v_mov_b32 v23, v22
    v_mov_b32 v18, 0
    v_mov_b32 v22, 0
    v_swap_b32 v16, v21
    v_swap_b32 v17, v25
    ds_write_b128 v14, v[18:21] offset:0
    s_mov_b64 exec, 0xffff
    ds_write_b128 v14, v[22:25] offset:1024
    s_mov_b64 exec, -1
    v_add_u32 v16, v16, v21
    v_add_u32 v17, v17, v25
    s_cmp_lg_u32 s82, 0
    s_cbranch_scc1 K2_RK2
    s_waitcnt vmcnt(2)
    v_cmp_ne_u32 vcc, 0, v58
    v_mov_b32 v15, 1
    s_cbranch_vccz K2_RK2
    ds_write_b32 v18, v15 offset:2184
K2_RK2:
    s_waitcnt lgkmcnt(0)
    s_branch K2_B15
K2_GE:
    s_setprio 3
    v_and_b32 v124, 15, v0
    v_lshrrev_b32 v125, 4, v0
    v_xor_b32 v125, v124, v125
    v_lshlrev_b32 v125, 4, v125
    v_lshl_add_u32 v52, v124, 8, v125
    v_xor_b32 v53, 64, v52
    v_xor_b32 v54, 0x80, v52
    v_xor_b32 v55, 0xc0, v52
    ds_read_b128 v[36:39], v52 offset:26112
    ds_read_b128 v[40:43], v53 offset:26112
    ds_read_b128 v[44:47], v54 offset:26112
    ds_read_b128 v[48:51], v55 offset:26112
    ds_read_b128 v[108:111], v52 offset:30208
    ds_read_b128 v[112:115], v53 offset:30208
    ds_read_b128 v[116:119], v54 offset:30208
    ds_read_b128 v[120:123], v55 offset:30208
    s_and_b32 s33, s28, 3
    s_lshl4_add_u32 s33, s33, 4352
    v_lshrrev_b32 v125, 4, v0
    v_lshl_add_u32 v125, v125, 2, s33
    v_mad_u32_u24 v56, v124, s83, v125
    s_mov_b32 s38, 0xbfb8aa3b
    v_mov_b32 v30, 0
    s_waitcnt lgkmcnt(4)
    v_mfma_f32_16x16x32_bf16 v[14:17], v[76:79], v[36:39], 0
    v_mfma_f32_16x16x32_bf16 v[18:21], v[92:95], v[36:39], 0
    v_mfma_f32_16x16x32_bf16 v[14:17], v[80:83], v[40:43], v[14:17]
    v_mfma_f32_16x16x32_bf16 v[18:21], v[96:99], v[40:43], v[18:21]
    v_mfma_f32_16x16x32_bf16 v[14:17], v[84:87], v[44:47], v[14:17]
    v_mfma_f32_16x16x32_bf16 v[18:21], v[100:103], v[44:47], v[18:21]
    v_mfma_f32_16x16x32_bf16 v[14:17], v[88:91], v[48:51], v[14:17]
    v_mfma_f32_16x16x32_bf16 v[18:21], v[104:107], v[48:51], v[18:21]
    s_waitcnt lgkmcnt(0)
    v_mfma_f32_16x16x32_bf16 v[22:25], v[76:79], v[108:111], 0
    ds_read_b128 v[36:39], v52 offset:34304
    ds_read_b128 v[40:43], v53 offset:34304
    v_mfma_f32_16x16x32_bf16 v[26:29], v[92:95], v[108:111], 0
    ds_read_b128 v[44:47], v54 offset:34304
    ds_read_b128 v[48:51], v55 offset:34304
    v_mfma_f32_16x16x32_bf16 v[22:25], v[80:83], v[112:115], v[22:25]
    v_mfma_f32_16x16x32_bf16 v[26:29], v[96:99], v[112:115], v[26:29]
    v_mul_f32 v14, s38, v14
    v_mul_f32 v15, s38, v15
    v_mul_f32 v16, s38, v16
    v_mfma_f32_16x16x32_bf16 v[22:25], v[84:87], v[116:119], v[22:25]
    v_mul_f32 v17, s38, v17
    v_min3_f32 v30, v30, v14, v15
    v_min3_f32 v30, v30, v16, v17
    v_mfma_f32_16x16x32_bf16 v[26:29], v[100:103], v[116:119], v[26:29]
    v_cvt_pk_bf16_f32 v14, v14, v18
    v_cvt_pk_bf16_f32 v15, v15, v19
    v_cvt_pk_bf16_f32 v16, v16, v20
    v_mfma_f32_16x16x32_bf16 v[22:25], v[88:91], v[120:123], v[22:25]
    v_cvt_pk_bf16_f32 v17, v17, v21
    ds_write2_b32 v56, v14, v15 offset0:0 offset1:16
    ds_write2_b32 v56, v16, v17 offset0:32 offset1:48
    v_mfma_f32_16x16x32_bf16 v[26:29], v[104:107], v[120:123], v[26:29]
    v_add_u32 v56, 4352, v56
    s_waitcnt lgkmcnt(2)
    v_mfma_f32_16x16x32_bf16 v[14:17], v[76:79], v[36:39], 0
    ds_read_b128 v[108:111], v52 offset:38400
    ds_read_b128 v[112:115], v53 offset:38400
    v_mfma_f32_16x16x32_bf16 v[18:21], v[92:95], v[36:39], 0
    ds_read_b128 v[116:119], v54 offset:38400
    ds_read_b128 v[120:123], v55 offset:38400
    v_mfma_f32_16x16x32_bf16 v[14:17], v[80:83], v[40:43], v[14:17]
    v_mfma_f32_16x16x32_bf16 v[18:21], v[96:99], v[40:43], v[18:21]
    v_mul_f32 v22, s38, v22
    v_mul_f32 v23, s38, v23
    v_mul_f32 v24, s38, v24
    v_mfma_f32_16x16x32_bf16 v[14:17], v[84:87], v[44:47], v[14:17]
    v_mul_f32 v25, s38, v25
    v_min3_f32 v30, v30, v22, v23
    v_min3_f32 v30, v30, v24, v25
    v_mfma_f32_16x16x32_bf16 v[18:21], v[100:103], v[44:47], v[18:21]
    v_cvt_pk_bf16_f32 v22, v22, v26
    v_cvt_pk_bf16_f32 v23, v23, v27
    v_cvt_pk_bf16_f32 v24, v24, v28
    v_mfma_f32_16x16x32_bf16 v[14:17], v[88:91], v[48:51], v[14:17]
    v_cvt_pk_bf16_f32 v25, v25, v29
    ds_write2_b32 v56, v22, v23 offset0:0 offset1:16
    ds_write2_b32 v56, v24, v25 offset0:32 offset1:48
    v_mfma_f32_16x16x32_bf16 v[18:21], v[104:107], v[48:51], v[18:21]
    v_add_u32 v56, 4352, v56
    s_waitcnt lgkmcnt(2)
    v_mfma_f32_16x16x32_bf16 v[22:25], v[76:79], v[108:111], 0
    ds_read_b128 v[36:39], v52 offset:42496
    ds_read_b128 v[40:43], v53 offset:42496
    v_mfma_f32_16x16x32_bf16 v[26:29], v[92:95], v[108:111], 0
    ds_read_b128 v[44:47], v54 offset:42496
    ds_read_b128 v[48:51], v55 offset:42496
    v_mfma_f32_16x16x32_bf16 v[22:25], v[80:83], v[112:115], v[22:25]
    v_mfma_f32_16x16x32_bf16 v[26:29], v[96:99], v[112:115], v[26:29]
    v_mul_f32 v14, s38, v14
    v_mul_f32 v15, s38, v15
    v_mul_f32 v16, s38, v16
    v_mfma_f32_16x16x32_bf16 v[22:25], v[84:87], v[116:119], v[22:25]
    v_mul_f32 v17, s38, v17
    v_min3_f32 v30, v30, v14, v15
    v_min3_f32 v30, v30, v16, v17
    v_mfma_f32_16x16x32_bf16 v[26:29], v[100:103], v[116:119], v[26:29]
    v_cvt_pk_bf16_f32 v14, v14, v18
    v_cvt_pk_bf16_f32 v15, v15, v19
    v_cvt_pk_bf16_f32 v16, v16, v20
    v_mfma_f32_16x16x32_bf16 v[22:25], v[88:91], v[120:123], v[22:25]
    v_cvt_pk_bf16_f32 v17, v17, v21
    ds_write2_b32 v56, v14, v15 offset0:0 offset1:16
    ds_write2_b32 v56, v16, v17 offset0:32 offset1:48
    v_mfma_f32_16x16x32_bf16 v[26:29], v[104:107], v[120:123], v[26:29]
    v_add_u32 v56, 4352, v56
    s_waitcnt lgkmcnt(2)
    v_mfma_f32_16x16x32_bf16 v[14:17], v[76:79], v[36:39], 0
    v_mfma_f32_16x16x32_bf16 v[18:21], v[92:95], v[36:39], 0
    v_mfma_f32_16x16x32_bf16 v[14:17], v[80:83], v[40:43], v[14:17]
    v_mfma_f32_16x16x32_bf16 v[18:21], v[96:99], v[40:43], v[18:21]
    v_mfma_f32_16x16x32_bf16 v[14:17], v[84:87], v[44:47], v[14:17]
    v_mfma_f32_16x16x32_bf16 v[18:21], v[100:103], v[44:47], v[18:21]
    v_mfma_f32_16x16x32_bf16 v[14:17], v[88:91], v[48:51], v[14:17]
    v_mul_f32 v22, s38, v22
    v_mul_f32 v23, s38, v23
    v_mfma_f32_16x16x32_bf16 v[18:21], v[104:107], v[48:51], v[18:21]
    v_mul_f32 v24, s38, v24
    v_mul_f32 v25, s38, v25
    v_min3_f32 v30, v30, v22, v23
    v_min3_f32 v30, v30, v24, v25
    v_cvt_pk_bf16_f32 v22, v22, v26
    v_cvt_pk_bf16_f32 v23, v23, v27
    v_cvt_pk_bf16_f32 v24, v24, v28
    v_cvt_pk_bf16_f32 v25, v25, v29
    ds_write2_b32 v56, v22, v23 offset0:0 offset1:16
    ds_write2_b32 v56, v24, v25 offset0:32 offset1:48
    v_add_u32 v56, 4352, v56
    s_nop 1
    v_mul_f32 v14, s38, v14
    v_mul_f32 v15, s38, v15
    v_mul_f32 v16, s38, v16
    v_mul_f32 v17, s38, v17
    v_min3_f32 v30, v30, v14, v15
    v_min3_f32 v30, v30, v16, v17
    v_cvt_pk_bf16_f32 v14, v14, v18
    v_cvt_pk_bf16_f32 v15, v15, v19
    v_cvt_pk_bf16_f32 v16, v16, v20
    v_cvt_pk_bf16_f32 v17, v17, v21
    ds_write2_b32 v56, v14, v15 offset0:0 offset1:16
    ds_write2_b32 v56, v16, v17 offset0:32 offset1:48
    v_cmp_gt_f32 vcc, 0xc2f00000, v30
    v_mov_b32 v30, 0
    v_mov_b32 v31, 1
    s_cbranch_vccz K2_GM
    ds_write_b32 v30, v31 offset:2184
    s_branch K2_GM
K2_RANK:
    v_lshlrev_b32 v14, 2, v0
    v_mov_b32 v15, 1
    v_mad_u32_u24 v24, v0, s83, 0
    v_lshl_or_b32 v24, v0, 16, v24
    v_add_u32 v26, 4211712, v24
    s_add_u32 s33, s30, 1
    s_mul_i32 s32, s33, 5120290
    s_add_u32 s32, s32, 65535
    s_lshr_b32 s32, s32, 16
    s_min_u32 s32, s32, 10000
    s_sub_u32 s32, s32, s31
    s_sub_u32 s32, s32, 64
    s_lshl_b32 s33, s31, 8
    s_lshl_b32 s34, s29, 7
    s_add_u32 s34, s33, s34
    v_lshl_add_u32 v25, v0, 8, s34
    v_add_u32 v27, 0x4000, v25
    v_cmp_gt_i32 vcc, s32, v0
    v_mov_b32 v28, 0x7ffff000
    s_movk_i32 s33, 256
    v_cndmask_b32 v27, v28, v27, vcc
    v_max_u32 v18, v16, v17
    v_cmp_lt_u32 vcc, s33, v18
    v_min_u32 v16, s33, v16
    v_min_u32 v17, s33, v17
    v_add_u32 v16, 4, v16
    v_add_u32 v17, 4, v17
    v_lshrrev_b32 v16, 3, v16
    v_lshrrev_b32 v17, 3, v17
    v_lshlrev_b32 v18, 2, v16
    v_lshlrev_b32 v19, 2, v17
    v_sub_u32 v18, 128, v18
    v_sub_u32 v19, 128, v19
    ds_add_rtn_u32 v20, v18, v15 offset:1280
    s_mov_b64 exec, 0xffff
    ds_add_rtn_u32 v21, v19, v15 offset:1280
    s_mov_b64 exec, -1
    ds_read_b32 v22, v14 offset:1280
    v_mov_b32 v28, 0
    s_cbranch_vccz K2_RK1
    ds_write_b32 v28, v15 offset:2176
K2_RK1:
    v_lshl_or_b32 v24, v16, 24, v24
    v_lshl_or_b32 v26, v17, 24, v26
    s_waitcnt lgkmcnt(0)
    v_mov_b32 v23, v22
    s_nop 1
    v_add_u32_dpp v22, v22, v22 row_shr:1 row_mask:0xf bank_mask:0xf
    s_nop 1
    v_add_u32_dpp v22, v22, v22 row_shr:2 row_mask:0xf bank_mask:0xf
    s_nop 1
    v_add_u32_dpp v22, v22, v22 row_shr:4 row_mask:0xf bank_mask:0xf
    s_nop 1
    v_add_u32_dpp v22, v22, v22 row_shr:8 row_mask:0xf bank_mask:0xf
    s_nop 1
    v_add_u32_dpp v22, v22, v22 row_bcast:15 row_mask:0xa bank_mask:0xf
    s_nop 1
    v_add_u32_dpp v22, v22, v22 row_bcast:31 row_mask:0xc bank_mask:0xf
    v_sub_u32 v22, v22, v23
    ds_bpermute_b32 v18, v18, v22
    ds_bpermute_b32 v19, v19, v22
    s_waitcnt lgkmcnt(0)
    v_add_lshl_u32 v20, v20, v18, 3
    v_add_lshl_u32 v21, v21, v19, 3
    ds_write_b64 v20, v[24:25] offset:1536
    s_mov_b64 exec, 0xffff
    ds_write_b64 v21, v[26:27] offset:1536
    s_mov_b64 exec, -1
    s_branch K2_RKD
K2_SAVE:
    s_mul_i32 s33, s2, 40960
    s_add_u32 s33, s33, 18874368
    v_bfe_u32 v30, v40, 16, 7
    v_lshl_add_u32 v30, v30, 8, v3
    v_lshl_add_u32 v30, v30, 1, s33
    global_store_dwordx4 v30, v[14:17], s[26:27]
    global_store_dwordx4 v30, v[18:21], s[26:27] offset:16
    s_sub_u32 s91, s91, 1
    s_mov_b32 s90, s94
    s_waitcnt vmcnt(0)
    s_branch K2_NEXT
K2_ACCLD:
    s_mul_i32 s33, s2, 40960
    s_add_u32 s33, s33, 18874368
    v_bfe_u32 v30, v40, 16, 7
    v_lshl_add_u32 v30, v30, 8, v3
    v_lshl_add_u32 v30, v30, 1, s33
    global_load_dwordx4 v[14:17], v30, s[26:27]
    global_load_dwordx4 v[18:21], v30, s[26:27] offset:16
    s_waitcnt vmcnt(0)
    s_waitcnt lgkmcnt(0)
    s_branch K2_ACCD
K2_XGF:
    s_waitcnt vmcnt(0)
    s_barrier
K2_XG:
    buffer_load_dwordx2 v[38:39], v41, s[40:43], 0 offen
    ds_read_u16_d16_hi v92, v42 offset:4352
    ds_read_u16_d16_hi v93, v42 offset:4352
    ds_read_u16_d16_hi v94, v42 offset:4352
    ds_read_u16_d16_hi v95, v42 offset:4352
    ds_read_u16_d16_hi v96, v42 offset:4416
    ds_read_u16_d16_hi v97, v42 offset:4416
    ds_read_u16_d16_hi v98, v42 offset:4416
    ds_read_u16_d16_hi v99, v42 offset:4416
    s_waitcnt lgkmcnt(4)
    ds_read_u16_d16_hi v100, v42 offset:4480
    ds_read_u16_d16_hi v101, v42 offset:4480
    ds_read_u16_d16_hi v102, v42 offset:4480
    ds_read_u16_d16_hi v103, v42 offset:4480
    ds_read_u16_d16_hi v104, v42 offset:4544
    ds_read_u16_d16_hi v105, v42 offset:4544
    ds_read_u16_d16_hi v106, v42 offset:4544
    ds_read_u16_d16_hi v107, v42 offset:4544
    s_max_u32 s96, s96, 1
    s_cmp_lg_u32 s80, 0
    s_cbranch_scc1 K2_XG1
    v_mov_b64 v[14:15], s[100:101]
    v_mov_b64 v[16:17], s[100:101]
    v_mov_b64 v[18:19], 0
    v_mov_b64 v[20:21], 0
    s_branch K2_XL
K2_XG1:
    s_mul_i32 s33, s2, 40960
    s_add_u32 s33, s33, 18874368
    v_bfe_u32 v30, v40, 16, 7
    v_lshl_add_u32 v30, v30, 8, v3
    v_lshl_add_u32 v30, v30, 1, s33
    global_load_dwordx4 v[14:17], v30, s[26:27]
    global_load_dwordx4 v[18:21], v30, s[26:27] offset:16
    s_waitcnt vmcnt(0)
K2_XL:
    s_waitcnt lgkmcnt(0)
    buffer_load_dwordx4 v[44:47], v[2:3], s[44:47], 0 idxen offen
    buffer_load_dwordx4 v[48:51], v[4:5], s[44:47], 0 idxen offen
    buffer_load_dwordx4 v[52:55], v[6:7], s[44:47], 0 idxen offen
    buffer_load_dwordx4 v[56:59], v[8:9], s[44:47], 0 idxen offen
    v_lshl_add_u32 v43, v10, 5, v11
    ds_read_b64 v[36:37], v43
    v_add_u32 v12, 16, v12
    v_add_u32 v13, 16, v13
    s_waitcnt lgkmcnt(0)
    v_mfma_f32_16x16x16_bf16 v[76:79], v[36:37], v[108:109], v[92:95]
    v_mfma_f32_16x16x16_bf16 v[80:83], v[36:37], v[110:111], v[96:99]
    v_mfma_f32_16x16x16_bf16 v[84:87], v[36:37], v[112:113], v[100:103]
    v_mfma_f32_16x16x16_bf16 v[88:91], v[36:37], v[114:115], v[104:107]
    ds_read_u16 v2, v12 offset:46594
    ds_read_u16 v4, v12 offset:46598
    ds_read_u16 v6, v12 offset:46602
    ds_read_u16 v8, v12 offset:46606
    ds_read_u16 v10, v13 offset:46592
    s_waitcnt vmcnt(0)
    v_lshlrev_b64 v[120:121], 16, v[44:45]
    v_lshlrev_b64 v[124:125], 16, v[48:49]
    v_lshlrev_b64 v[122:123], 16, v[46:47]
    v_lshlrev_b64 v[126:127], 16, v[50:51]
    v_log_f32 v22, v120
    v_cmp_gt_i32 vcc, 0, v120
    v_lshlrev_b32 v120, 1, v120
    v_add_f32 v22, 0x42200000, v22
    v_cndmask_b32 v22, v22, v120, vcc
    v_add_f32 v22, v22, v76
    v_exp_f32 v22, v22
    v_log_f32 v23, v121
    v_cmp_gt_i32 vcc, 0, v121
    v_lshlrev_b32 v121, 1, v121
    v_add_f32 v23, 0x42200000, v23
    v_cndmask_b32 v23, v23, v121, vcc
    v_add_f32 v23, v23, v80
    v_exp_f32 v23, v23
    v_log_f32 v24, v122
    v_cmp_gt_i32 vcc, 0, v122
    v_lshlrev_b32 v122, 1, v122
    v_add_f32 v24, 0x42200000, v24
    v_cndmask_b32 v24, v24, v122, vcc
    v_add_f32 v24, v24, v84
    v_exp_f32 v24, v24
    v_log_f32 v25, v123
    v_cmp_gt_i32 vcc, 0, v123
    v_lshlrev_b32 v123, 1, v123
    v_add_f32 v25, 0x42200000, v25
    v_cndmask_b32 v25, v25, v123, vcc
    v_add_f32 v25, v25, v88
    v_exp_f32 v25, v25
    v_log_f32 v26, v124
    v_cmp_gt_i32 vcc, 0, v124
    v_lshlrev_b32 v124, 1, v124
    v_add_f32 v26, 0x42200000, v26
    v_cndmask_b32 v26, v26, v124, vcc
    v_add_f32 v26, v26, v77
    v_exp_f32 v26, v26
    v_log_f32 v27, v125
    v_cmp_gt_i32 vcc, 0, v125
    v_lshlrev_b32 v125, 1, v125
    v_add_f32 v27, 0x42200000, v27
    v_cndmask_b32 v27, v27, v125, vcc
    v_add_f32 v27, v27, v81
    v_exp_f32 v27, v27
    v_log_f32 v28, v126
    v_cmp_gt_i32 vcc, 0, v126
    v_lshlrev_b32 v126, 1, v126
    v_add_f32 v28, 0x42200000, v28
    v_cndmask_b32 v28, v28, v126, vcc
    v_add_f32 v28, v28, v85
    v_exp_f32 v28, v28
    v_log_f32 v29, v127
    v_cmp_gt_i32 vcc, 0, v127
    v_lshlrev_b32 v127, 1, v127
    v_add_f32 v29, 0x42200000, v29
    v_cndmask_b32 v29, v29, v127, vcc
    v_add_f32 v29, v29, v89
    v_exp_f32 v29, v29
    s_nop 0
    v_pk_fma_f32 v[22:23], v[22:23], v[34:35], v[34:35] op_sel_hi:[1,0,0] clamp
    v_pk_fma_f32 v[26:27], v[26:27], v[34:35], v[34:35] op_sel_hi:[1,0,0] clamp
    v_pk_fma_f32 v[24:25], v[24:25], v[34:35], v[34:35] op_sel_hi:[1,0,0] clamp
    v_pk_fma_f32 v[28:29], v[28:29], v[34:35], v[34:35] op_sel_hi:[1,0,0] clamp
    v_pk_mul_f32 v[30:31], v[22:23], v[26:27]
    v_pk_mul_f32 v[32:33], v[24:25], v[28:29]
    v_pk_mul_f32 v[116:117], v[44:45], v[26:27]
    v_pk_mul_f32 v[118:119], v[46:47], v[28:29]
    v_pk_fma_f32 v[116:117], v[48:49], v[22:23], v[116:117]
    v_pk_fma_f32 v[118:119], v[50:51], v[24:25], v[118:119]
    v_rcp_f32 v30, v30
    v_rcp_f32 v31, v31
    v_rcp_f32 v32, v32
    v_rcp_f32 v33, v33
    s_nop 0
    v_pk_add_f32 v[22:23], v[22:23], v[26:27]
    v_pk_add_f32 v[24:25], v[24:25], v[28:29]
    v_pk_fma_f32 v[18:19], v[116:117], v[30:31], v[18:19]
    v_pk_fma_f32 v[20:21], v[118:119], v[32:33], v[20:21]
    v_pk_fma_f32 v[14:15], v[22:23], v[30:31], v[14:15]
    v_pk_fma_f32 v[16:17], v[24:25], v[32:33], v[16:17]
    v_lshlrev_b64 v[120:121], 16, v[52:53]
    v_lshlrev_b64 v[124:125], 16, v[56:57]
    v_lshlrev_b64 v[122:123], 16, v[54:55]
    v_lshlrev_b64 v[126:127], 16, v[58:59]
    v_log_f32 v22, v120
    v_cmp_gt_i32 vcc, 0, v120
    v_lshlrev_b32 v120, 1, v120
    v_add_f32 v22, 0x42200000, v22
    v_cndmask_b32 v22, v22, v120, vcc
    v_add_f32 v22, v22, v78
    v_exp_f32 v22, v22
    v_log_f32 v23, v121
    v_cmp_gt_i32 vcc, 0, v121
    v_lshlrev_b32 v121, 1, v121
    v_add_f32 v23, 0x42200000, v23
    v_cndmask_b32 v23, v23, v121, vcc
    v_add_f32 v23, v23, v82
    v_exp_f32 v23, v23
    v_log_f32 v24, v122
    v_cmp_gt_i32 vcc, 0, v122
    v_lshlrev_b32 v122, 1, v122
    v_add_f32 v24, 0x42200000, v24
    v_cndmask_b32 v24, v24, v122, vcc
    v_add_f32 v24, v24, v86
    v_exp_f32 v24, v24
    v_log_f32 v25, v123
    v_cmp_gt_i32 vcc, 0, v123
    v_lshlrev_b32 v123, 1, v123
    v_add_f32 v25, 0x42200000, v25
    v_cndmask_b32 v25, v25, v123, vcc
    v_add_f32 v25, v25, v90
    v_exp_f32 v25, v25
    v_log_f32 v26, v124
    v_cmp_gt_i32 vcc, 0, v124
    v_lshlrev_b32 v124, 1, v124
    v_add_f32 v26, 0x42200000, v26
    v_cndmask_b32 v26, v26, v124, vcc
    v_add_f32 v26, v26, v79
    v_exp_f32 v26, v26
    v_log_f32 v27, v125
    v_cmp_gt_i32 vcc, 0, v125
    v_lshlrev_b32 v125, 1, v125
    v_add_f32 v27, 0x42200000, v27
    v_cndmask_b32 v27, v27, v125, vcc
    v_add_f32 v27, v27, v83
    v_exp_f32 v27, v27
    v_log_f32 v28, v126
    v_cmp_gt_i32 vcc, 0, v126
    v_lshlrev_b32 v126, 1, v126
    v_add_f32 v28, 0x42200000, v28
    v_cndmask_b32 v28, v28, v126, vcc
    v_add_f32 v28, v28, v87
    v_exp_f32 v28, v28
    v_log_f32 v29, v127
    v_cmp_gt_i32 vcc, 0, v127
    v_lshlrev_b32 v127, 1, v127
    v_add_f32 v29, 0x42200000, v29
    v_cndmask_b32 v29, v29, v127, vcc
    v_add_f32 v29, v29, v91
    v_exp_f32 v29, v29
    s_nop 0
    v_pk_fma_f32 v[22:23], v[22:23], v[34:35], v[34:35] op_sel_hi:[1,0,0] clamp
    v_pk_fma_f32 v[26:27], v[26:27], v[34:35], v[34:35] op_sel_hi:[1,0,0] clamp
    v_pk_fma_f32 v[24:25], v[24:25], v[34:35], v[34:35] op_sel_hi:[1,0,0] clamp
    v_pk_fma_f32 v[28:29], v[28:29], v[34:35], v[34:35] op_sel_hi:[1,0,0] clamp
    v_pk_mul_f32 v[30:31], v[22:23], v[26:27]
    v_pk_mul_f32 v[32:33], v[24:25], v[28:29]
    v_pk_mul_f32 v[116:117], v[52:53], v[26:27]
    v_pk_mul_f32 v[118:119], v[54:55], v[28:29]
    v_pk_fma_f32 v[116:117], v[56:57], v[22:23], v[116:117]
    v_pk_fma_f32 v[118:119], v[58:59], v[24:25], v[118:119]
    v_rcp_f32 v30, v30
    v_rcp_f32 v31, v31
    v_rcp_f32 v32, v32
    v_rcp_f32 v33, v33
    s_nop 0
    v_pk_add_f32 v[22:23], v[22:23], v[26:27]
    v_pk_add_f32 v[24:25], v[24:25], v[28:29]
    v_pk_fma_f32 v[18:19], v[116:117], v[30:31], v[18:19]
    v_pk_fma_f32 v[20:21], v[118:119], v[32:33], v[20:21]
    v_pk_fma_f32 v[14:15], v[22:23], v[30:31], v[14:15]
    v_pk_fma_f32 v[16:17], v[24:25], v[32:33], v[16:17]
    s_sub_u32 s96, s96, 1
    s_cmp_lg_u32 s96, 0
    s_cbranch_scc1 K2_XL
    s_waitcnt lgkmcnt(0)
    s_branch K2_FIN
K2_SLOWDEC:
    s_mov_b32 s81, 0
    s_mov_b32 s86, 0
    s_cmp_lg_u32 s33, 0
    s_cbranch_scc1 K2_GO
    s_mov_b32 s86, 1
    s_add_u32 s85, s85, 16
    s_cmp_ge_u32 s85, s87
    s_cselect_b32 s81, 1, 0
    s_branch K2_GO
K2_SLOWINIT:
    s_mov_b32 s82, 1
    s_mov_b32 s85, 0
    s_mov_b32 s86, 1
    s_max_u32 s87, s89, 64
K2_SLOWROUND:
    s_waitcnt vmcnt(0) lgkmcnt(0)
    s_barrier
    s_sub_u32 s33, s28, 4
    s_cmp_ge_u32 s33, 8
    s_cbranch_scc1 K2_SL1
    s_lshl_b32 s33, s33, 10
    v_lshl_add_u32 v60, v0, 4, s33
    v_mov_b32 v64, 0x27100ba7
    v_mov_b32 v65, v64
    v_mov_b64 v[66:67], v[64:65]
    ds_write_b128 v60, v[64:67] offset:46592
    ds_write_b128 v60, v[64:67] offset:54784
    ds_write_b128 v60, v[64:67] offset:60160
    s_cmp_ge_u32 s28, 8
    s_cbranch_scc1 K2_SL1
    v_mov_b64 v[68:69], 0
    v_mov_b64 v[70:71], 0
    v_min_u32 v61, 2288, v60
    ds_write_b128 v61, v[68:71]
    v_and_b32 v62, 16, v60
    v_add_u32 v62, 163808, v62
    ds_write_b128 v62, v[68:71]
K2_SL1:
    s_lshl_b32 s33, s28, 10
    s_add_u32 s33, s33, s30
    s_lshl3_add_u32 s33, s33, 17829888
    v_lshrrev_b32 v124, 5, v0
    v_lshl_add_u32 v125, v124, 10, s33
    global_load_dwordx2 v[64:65], v125, s[26:27] offset:-4096
    global_load_dwordx2 v[66:67], v125, s[26:27] offset:-2048
    global_load_dwordx2 v[68:69], v125, s[26:27] offset:0
    global_load_dwordx2 v[70:71], v125, s[26:27] offset:2048
    v_and_b32 v57, 31, v0
    v_add_u32 v57, s85, v57
    s_lshl_b32 s62, s28, 10
    s_add_u32 s62, s62, 26112
    v_lshrrev_b32 v126, 1, v0
    v_lshl_add_u32 v126, v126, 2, s62
    v_and_b32 v127, 1, v0
    v_lshlrev_b32 v127, 4, v127
    s_waitcnt vmcnt(0)
    v_lshl_add_u32 v18, v57, 2, v64
    v_lshl_add_u32 v19, v57, 2, v66
    v_lshl_add_u32 v20, v57, 2, v68
    v_lshl_add_u32 v21, v57, 2, v70
    s_cmp_eq_u32 s86, 0
    s_cbranch_scc1 K2_SL2
    v_cmp_lt_u32 s[64:65], v57, v65
    v_cmp_lt_u32 s[66:67], v57, v67
    v_cmp_lt_u32 s[68:69], v57, v69
    v_cmp_lt_u32 s[70:71], v57, v71
    s_mov_b32 s34, 0xffff
    s_mov_b32 s35, 0xffff
    s_nop 2
    s_and_b64 s[64:65], s[64:65], s[34:35]
    s_and_b64 s[66:67], s[66:67], s[34:35]
    s_and_b64 s[68:69], s[68:69], s[34:35]
    s_and_b64 s[70:71], s[70:71], s[34:35]
K2_SL2:
    s_mov_b64 exec, s[64:65]
    global_load_dword v26, v18, s[60:61]
    s_mov_b64 exec, s[66:67]
    global_load_dword v27, v19, s[60:61]
    s_mov_b64 exec, s[68:69]
    global_load_dword v28, v20, s[60:61]
    s_mov_b64 exec, s[70:71]
    global_load_dword v29, v21, s[60:61]
    s_mov_b64 exec, -1
    s_mov_b32 s52, 0
    s_waitcnt lgkmcnt(0)
    s_barrier
    s_bcnt1_i32_b64 s33, s[64:65]
    s_add_u32 s53, s52, s33
    s_bcnt1_i32_b64 s33, s[66:67]
    s_add_u32 s54, s53, s33
    s_bcnt1_i32_b64 s33, s[68:69]
    s_add_u32 s55, s54, s33
    s_bcnt1_i32_b64 s33, s[70:71]
    s_add_u32 s63, s55, s33
    s_add_u32 s34, s63, 31
    s_and_b32 s34, s34, 0xffe0
    v_mov_b32 v124, s34
    v_mov_b32 v125, 0
    s_mov_b64 exec, 1
    ds_add_rtn_u32 v124, v125, v124 offset:2188
    s_cmp_gt_u32 s63, 256
    s_cbranch_scc1 K2_SS_w
    s_mov_b64 exec, s[64:65]
    s_lshl2_add_u32 s33, s52, s62
    v_mbcnt_lo_u32_b32 v108, exec_lo, 0
    v_mbcnt_hi_u32_b32 v108, exec_hi, v108
    v_lshl_add_u32 v44, v108, 2, s33
    ds_write_b32 v44, v18
    s_mov_b64 exec, s[66:67]
    s_lshl2_add_u32 s33, s53, s62
    v_mbcnt_lo_u32_b32 v109, exec_lo, 0
    v_mbcnt_hi_u32_b32 v109, exec_hi, v109
    v_lshl_add_u32 v45, v109, 2, s33
    ds_write_b32 v45, v19
    s_mov_b64 exec, s[68:69]
    s_lshl2_add_u32 s33, s54, s62
    v_mbcnt_lo_u32_b32 v110, exec_lo, 0
    v_mbcnt_hi_u32_b32 v110, exec_hi, v110
    v_lshl_add_u32 v46, v110, 2, s33
    ds_write_b32 v46, v20
    s_mov_b64 exec, s[70:71]
    s_lshl2_add_u32 s33, s55, s62
    v_mbcnt_lo_u32_b32 v111, exec_lo, 0
    v_mbcnt_hi_u32_b32 v111, exec_hi, v111
    v_lshl_add_u32 v47, v111, 2, s33
    ds_write_b32 v47, v21
K2_SS_w:
    s_mov_b64 exec, -1
    ds_read2_b32 v[60:61], v126 offset0:0 offset1:32
    ds_read2_b32 v[62:63], v126 offset0:64 offset1:96
    ds_read2_b32 v[64:65], v126 offset0:128 offset1:160
    ds_read2_b32 v[66:67], v126 offset0:192 offset1:224
    s_cmp_gt_u32 s63, 256
    s_cselect_b32 s35, 0x10000, s34
    s_lshr_b32 s63, s34, 5
    s_waitcnt lgkmcnt(2)
    v_readfirstlane_b32 s36, v124
    s_add_u32 s35, s35, s36
    s_cmp_le_u32 s35, 2976
    s_cbranch_scc1 K2_SS_ok
    v_mov_b32 v124, 1
    ds_write_b32 v125, v124 offset:2176
    s_mov_b32 s63, 0
K2_SS_ok:
    s_lshl_b32 s39, s36, 5
    s_add_u32 s39, s39, 68352
    s_waitcnt lgkmcnt(0)
    s_cmp_le_u32 s63, 0
    s_cbranch_scc1 K2_SR
    s_add_u32 m0, s39, 0
    v_lshl_add_u32 v60, v60, 3, v127
    buffer_load_dwordx4 v60, s[48:51], 0 offen  lds
    s_cmp_le_u32 s63, 1
    s_cbranch_scc1 K2_SR
    s_add_u32 m0, s39, 1024
    v_lshl_add_u32 v61, v61, 3, v127
    buffer_load_dwordx4 v61, s[48:51], 0 offen  lds
    s_cmp_le_u32 s63, 2
    s_cbranch_scc1 K2_SR
    s_add_u32 m0, s39, 2048
    v_lshl_add_u32 v62, v62, 3, v127
    buffer_load_dwordx4 v62, s[48:51], 0 offen  lds
    s_cmp_le_u32 s63, 3
    s_cbranch_scc1 K2_SR
    s_add_u32 m0, s39, 3072
    v_lshl_add_u32 v63, v63, 3, v127
    buffer_load_dwordx4 v63, s[48:51], 0 offen  lds
    s_cmp_le_u32 s63, 4
    s_cbranch_scc1 K2_SR
    s_add_u32 m0, s39, 4096
    v_lshl_add_u32 v64, v64, 3, v127
    buffer_load_dwordx4 v64, s[48:51], 0 offen  lds
    s_cmp_le_u32 s63, 5
    s_cbranch_scc1 K2_SR
    s_add_u32 m0, s39, 5120
    v_lshl_add_u32 v65, v65, 3, v127
    buffer_load_dwordx4 v65, s[48:51], 0 offen  lds
    s_cmp_le_u32 s63, 6
    s_cbranch_scc1 K2_SR
    s_add_u32 m0, s39, 6144
    v_lshl_add_u32 v66, v66, 3, v127
    buffer_load_dwordx4 v66, s[48:51], 0 offen  lds
    s_cmp_le_u32 s63, 7
    s_cbranch_scc1 K2_SR
    s_add_u32 m0, s39, 7168
    v_lshl_add_u32 v67, v67, 3, v127
    buffer_load_dwordx4 v67, s[48:51], 0 offen  lds
K2_SR:
    s_add_u32 s33, s52, s36
    v_add_u32 v108, s33, v108
    s_add_u32 s33, s53, s36
    v_add_u32 v109, s33, v109
    s_add_u32 s33, s54, s36
    v_add_u32 v110, s33, v110
    s_add_u32 s33, s55, s36
    v_add_u32 v111, s33, v111
    s_cmp_ge_u32 s28, 8
    s_cselect_b32 s34, 0x4080605, 0
    s_cselect_b32 s35, 0xb09070a, 0
    s_cselect_b32 s36, 0, 0xd0c0e12
    s_cselect_b32 s37, 0, 0x2010300
    s_or_b64 s[34:35], s[34:35], s[36:37]
    s_lshl_b32 s33, s28, 3
    s_lshr_b64 s[34:35], s[34:35], s33
    s_and_b32 s90, s34, 31
    s_lshr_b32 s94, 0x10110f13, s33
    s_and_b32 s94, s94, 31
    s_cmp_lt_u32 s28, 4
    s_cselect_b32 s91, 2, 1
    s_mul_i32 s33, s29, 2560256
    s_add_u32 s44, s26, s33
    s_addc_u32 s45, s27, 0
    s_or_b32 s45, s45, 0x01000000
    s_mov_b32 s46, 2560256
    s_mov_b32 s47, 0x20000
    s_mov_b32 s100, 0x498637bd
    s_mov_b32 s101, 0x498637bd
    s_movk_i32 s95, 0x3f80
    s_mov_b32 s92, 0x3f800000
    s_mov_b32 s52, s22
    s_mov_b32 s53, s23
    s_mov_b32 s54, 2560000
    s_mov_b32 s55, 0x20000
    v_mov_b32 v124, 4
    s_waitcnt vmcnt(0)
    s_mov_b64 exec, s[64:65]
    v_and_b32 v44, 0x7fc, v26
    ds_add_rtn_u32 v36, v44, v124 offset:0
    s_mov_b64 exec, s[66:67]
    v_and_b32 v45, 0x7fc, v27
    ds_add_rtn_u32 v37, v45, v124 offset:0
    s_mov_b64 exec, s[68:69]
    v_and_b32 v46, 0x7fc, v28
    ds_add_rtn_u32 v38, v46, v124 offset:0
    s_mov_b64 exec, s[70:71]
    v_and_b32 v47, 0x7fc, v29
    ds_add_rtn_u32 v39, v47, v124 offset:0
    s_mov_b64 exec, -1
    s_waitcnt lgkmcnt(0)
    s_branch K2_B1
K2_SSC:
    s_mov_b64 exec, s[64:65]
    ds_read_b32 v44, v44 offset:0
    s_mov_b64 exec, s[66:67]
    ds_read_b32 v45, v45 offset:0
    s_mov_b64 exec, s[68:69]
    ds_read_b32 v46, v46 offset:0
    s_mov_b64 exec, s[70:71]
    ds_read_b32 v47, v47 offset:0
    s_movk_i32 s33, 256
    s_waitcnt lgkmcnt(0)
    s_mov_b64 exec, s[64:65]
    v_add_u32 v36, v36, v44
    v_cmp_gt_u32 vcc, s33, v36
    s_andn2_b64 s[64:65], exec, vcc
    s_and_b64 exec, exec, vcc
    v_and_b32 v125, 0x7f0, v26
    v_and_or_b32 v108, v26, s84, v108
    v_mad_u32_u24 v36, v125, 17, v36
    ds_write_b32 v36, v108 offset:46592
    s_mov_b64 exec, s[66:67]
    v_add_u32 v37, v37, v45
    v_cmp_gt_u32 vcc, s33, v37
    s_andn2_b64 s[66:67], exec, vcc
    s_and_b64 exec, exec, vcc
    v_and_b32 v125, 0x7f0, v27
    v_and_or_b32 v109, v27, s84, v109
    v_mad_u32_u24 v37, v125, 17, v37
    ds_write_b32 v37, v109 offset:46592
    s_mov_b64 exec, s[68:69]
    v_add_u32 v38, v38, v46
    v_cmp_gt_u32 vcc, s33, v38
    s_andn2_b64 s[68:69], exec, vcc
    s_and_b64 exec, exec, vcc
    v_and_b32 v125, 0x7f0, v28
    v_and_or_b32 v110, v28, s84, v110
    v_mad_u32_u24 v38, v125, 17, v38
    ds_write_b32 v38, v110 offset:46592
    s_mov_b64 exec, s[70:71]
    v_add_u32 v39, v39, v47
    v_cmp_gt_u32 vcc, s33, v39
    s_andn2_b64 s[70:71], exec, vcc
    s_and_b64 exec, exec, vcc
    v_and_b32 v125, 0x7f0, v29
    v_and_or_b32 v111, v29, s84, v111
    v_mad_u32_u24 v39, v125, 17, v39
    ds_write_b32 v39, v111 offset:46592
    s_branch K2_SCD
K2_END:
    s_endpgm
.section .rodata,"a"
.p2align 6
.amdhsa_kernel gcn_prep_kernel
  .amdhsa_next_free_vgpr 96
  .amdhsa_next_free_sgpr 102
  .amdhsa_accum_offset 96
  .amdhsa_group_segment_fixed_size 0
  .amdhsa_kernarg_size 96
  .amdhsa_user_sgpr_count 2
  .amdhsa_user_sgpr_kernarg_segment_ptr 1
  .amdhsa_system_sgpr_workgroup_id_x 1
  .amdhsa_float_denorm_mode_32 3
.end_amdhsa_kernel
.p2align 6
.amdhsa_kernel gcn_main_kernel
  .amdhsa_next_free_vgpr 128
  .amdhsa_next_free_sgpr 102
  .amdhsa_accum_offset 128
  .amdhsa_group_segment_fixed_size 0
  .amdhsa_kernarg_size 96
  .amdhsa_user_sgpr_count 2
  .amdhsa_user_sgpr_kernarg_segment_ptr 1
  .amdhsa_system_sgpr_workgroup_id_x 1
  .amdhsa_float_denorm_mode_32 3
.end_amdhsa_kernel
```
